```python
import torch

def _softmax(x, axis=-1):
    return torch.softmax(x, dim=axis)
def _gelu(x):
    return torch.nn.functional.gelu(x, approximate="tanh")
def _silu(x):
    return torch.nn.functional.silu(x)
def _sigmoid(x):
    return torch.sigmoid(x)
def _layernorm(x, axis=-1, eps=1e-5):
    m = x.mean(dim=axis, keepdim=True)
    v = x.var(dim=axis, keepdim=True, unbiased=False)
    return (x - m) / torch.sqrt(v + eps)
def _scatter_add(tgt, idx, src, axis=0):
    return tgt.clone().index_add_(axis, idx, src)
def _segment_sum(src, seg, n):
    out = torch.zeros((n,) + src.shape[1:], dtype=src.dtype)
    return out.index_add_(0, seg, src)
def _pad(x, pw):
    flat = tuple(v for pair in reversed(pw) for v in pair)
    return torch.nn.functional.pad(x, flat)

kernel_name = 'interleave_layers__sliding_block__dense_activation_squared_relu__prompt'

def setup_inputs():

    _w = (lambda a: (lambda t: t.to(torch.bfloat16) if t.is_floating_point() else t)(torch.as_tensor(a)))
    def _A_setup():
        B, S, D = 1, 2048, 512
        return {
            "x": _w((lambda *s: torch.randn(*s, dtype=torch.bfloat16) * 0.05)(B, S, D)),
            "wqkv": _w((lambda *s: torch.randn(*s, dtype=torch.bfloat16) * 0.05)(D, 3 * D)),
            "wo": _w((lambda *s: torch.randn(*s, dtype=torch.bfloat16) * 0.05)(D, D)),
        }
    _A_in = _A_setup()

    def _B_setup():
        B, S, D, F = 1, 2048, 512, 1792
        return {
            "x": _w((lambda *s: torch.randn(*s, dtype=torch.bfloat16) * 0.05)(B, S, D)),
            "w1": _w((lambda *s: torch.randn(*s, dtype=torch.bfloat16) * 0.05)(D, F)),
            "b1": _w((lambda *s: torch.randn(*s, dtype=torch.bfloat16) * 0.2)(F)),
            "w2": _w((lambda *s: torch.randn(*s, dtype=torch.bfloat16) * 0.05)(F, D)),
            "b2": _w((lambda *s: torch.randn(*s, dtype=torch.bfloat16) * 0.8)(D)),
        }
    _B_in = _B_setup()

    return {
        "A_x": _A_in["x"],
        "A_wqkv": _A_in["wqkv"],
        "A_wo": _A_in["wo"],
        "B_x": _B_in["x"],
        "B_w1": _B_in["w1"],
        "B_b1": _B_in["b1"],
        "B_w2": _B_in["w2"],
        "B_b2": _B_in["b2"],
    }

def reference(A_x, A_wqkv, A_wo, B_x, B_w1, B_b1, B_w2, B_b2):
    def _A_ref(x, wqkv, wo):
        B, S, D = x.shape
        H = 32; Dh = D // H; W = 256
        qkv = (lambda x, *d: x.permute(*d))((x @ wqkv).reshape(B, S, 3, H, Dh), 2, 0, 3, 1, 4)
        q, k, v = qkv[0], qkv[1], qkv[2]
        scores = torch.einsum("bhqd,bhkd->bhqk", q, k) * (Dh ** -0.5)
        idx = torch.arange(S)
        mask = (idx[:, None] - idx[None, :] >= 0) & (idx[:, None] - idx[None, :] < W)
        scores = torch.where(mask[None, None], scores, -1e9)
        p = _softmax(scores, axis=-1)
        o = torch.einsum("bhqk,bhkd->bhqd", p, v)
        return (lambda x, *d: x.permute(*d))(o, 0, 2, 1, 3).reshape(B, S, D) @ wo

    def _B_ref(x, w1, b1, w2, b2):
        h = torch.einsum("bsd,df->bsf", x, w1) + b1
        zero = torch.zeros_like(h)
        r = torch.where(h > zero, h, zero)
        h = r * r
        out = torch.einsum("bsf,fd->bsd", h, w2) + b2
        return out

    x = A_x
    x = x + _A_ref(_layernorm(x, axis=-1), A_wqkv, A_wo)
    x = x + _B_ref(_layernorm(x, axis=-1), B_w1, B_b1, B_w2, B_b2)
    x = x + _A_ref(_layernorm(x, axis=-1), A_wqkv, A_wo)
    x = x + _B_ref(_layernorm(x, axis=-1), B_w1, B_b1, B_w2, B_b2)
    return x
```

```asm
; @launch grid=(256,1,1) block=(512,1,1) lds=163840
.amdgcn_target "amdgcn-amd-amdhsa--gfx950"
.text
.globl interleave_layers__sliding_block__dense_activation_squared_relu__prompt_kernel
.p2align 8
.type interleave_layers__sliding_block__dense_activation_squared_relu__prompt_kernel,@function
interleave_layers__sliding_block__dense_activation_squared_relu__prompt_kernel:
  s_cmp_ge_u32 s2, 256
  s_cbranch_scc1 L_END
  s_load_dwordx16 s[64:79], s[0:1], 0
  s_load_dwordx4 s[80:83], s[0:1], 64
  s_load_dwordx2 s[84:85], s[0:1], 80
  v_lshrrev_b32 v1, 6, v0
  v_and_b32 v0, 63, v0
  v_readfirstlane_b32 s6, v1
  s_and_b32 s4, s2, 7
  s_lshl_b32 s4, s4, 1
  s_lshr_b32 s5, s2, 3
  s_lshr_b32 s46, s5, 4
  s_add_u32 s4, s4, s46
  s_and_b32 s5, s5, 15
  s_mov_b32 s3, 0
  s_mov_b32 s46, 1
  s_mov_b32 s7, 0
  s_lshl_b32 s47, s4, 12
  s_mov_b32 s100, 0x3f803f80
  v_lshlrev_b32 v1, 4, v0
  v_and_b32 v10, 15, v0
  v_lshlrev_b32 v10, 2, v10
  v_mov_b32 v11, 0
  v_mov_b32 v2, 0
  v_mov_b32 v3, 0
  v_mov_b32 v4, 0
  v_mov_b32 v5, 0
  v_mov_b32 v6, 0
  v_mov_b32 v7, 0
  v_mov_b32 v8, 0
  v_mov_b32 v9, 0
  v_mov_b32 v22, 0
  v_mov_b32 v23, 0
  v_mov_b32 v24, 0
  v_mov_b32 v25, 0
  v_mov_b32 v26, 0
  v_mov_b32 v27, 0
  s_waitcnt lgkmcnt(0)
  s_mov_b32 s8, s64
  s_and_b32 s9, s65, 0xffff
  s_mov_b32 s10, 2097152
  s_mov_b32 s11, 0x20000
  s_mov_b32 s12, s66
  s_and_b32 s13, s67, 0xffff
  s_mov_b32 s14, 1572864
  s_mov_b32 s15, 0x20000
  s_mov_b32 s16, s68
  s_and_b32 s17, s69, 0xffff
  s_mov_b32 s18, 524288
  s_mov_b32 s19, 0x20000
  s_mov_b32 s20, s72
  s_and_b32 s21, s73, 0xffff
  s_mov_b32 s22, 1835008
  s_mov_b32 s23, 0x20000
  s_mov_b32 s24, s76
  s_and_b32 s25, s77, 0xffff
  s_mov_b32 s26, 1835008
  s_mov_b32 s27, 0x20000
  s_mov_b32 s28, s84
  s_and_b32 s29, s85, 0xffff
  s_mov_b32 s30, 268435456
  s_mov_b32 s31, 0x20000
  s_mov_b32 s32, s80
  s_and_b32 s33, s81, 0xffff
  s_mov_b32 s34, 2097152
  s_mov_b32 s35, 0x20000
  s_mov_b32 s40, s78
  s_mov_b32 s41, s79
  s_mov_b32 s42, s74
  s_mov_b32 s43, s75
  s_mov_b32 s44, s82
  s_mov_b32 s45, s83
  v_and_b32 v2, 31, v0
  v_lshrrev_b32 v3, 5, v0
  v_lshlrev_b32 v3, 2, v3
  v_sub_u32 v2, v2, v3
  v_cmp_le_i32 s[48:49], 0, v2
  v_cmp_le_i32 s[50:51], 1, v2
  v_cmp_le_i32 s[52:53], 2, v2
  v_cmp_le_i32 s[54:55], 3, v2
  v_cmp_le_i32 s[56:57], 8, v2
  v_cmp_le_i32 s[58:59], 9, v2
  v_cmp_le_i32 s[60:61], 10, v2
  v_cmp_le_i32 s[62:63], 11, v2
  v_cmp_le_i32 s[64:65], 16, v2
  v_cmp_le_i32 s[66:67], 17, v2
  v_cmp_le_i32 s[68:69], 18, v2
  v_cmp_le_i32 s[70:71], 19, v2
  v_cmp_le_i32 s[72:73], 24, v2
  v_cmp_le_i32 s[74:75], 25, v2
  v_cmp_le_i32 s[76:77], 26, v2
  v_cmp_le_i32 s[78:79], 27, v2
  s_cmp_ge_u32 s6, 4
  s_cbranch_scc1 L_HELPER
L_CLAYER:
  v_and_b32 v16, 15, v0
  v_lshrrev_b32 v16, 2, v16
  v_lshlrev_b32 v16, 6, v16
  v_lshrrev_b32 v17, 4, v0
  v_and_b32 v17, 1, v17
  v_lshlrev_b32 v17, 5, v17
  v_add_u32 v16, v16, v17
  v_and_b32 v17, 3, v0
  v_lshlrev_b32 v17, 3, v17
  v_add_u32 v16, v16, v17
  v_lshrrev_b32 v17, 5, v0
  s_movk_i32 s82, 256
  s_movk_i32 s83, 512
  s_cmp_eq_u32 s3, 0
  s_cselect_b32 s80, s83, s82
  s_cselect_b32 s81, s82, s83
  v_mul_lo_u32 v17, v17, s80
  v_add_u32 v12, v16, v17
  v_add_u32 v13, s81, v12
  v_add_u32 v14, 0x10000, v12
  v_add_u32 v15, 0x10000, v13
  v_and_b32 v44, 31, v0
  v_lshlrev_b32 v44, 2, v44
  v_add_u32 v44, 160256, v44
  s_lshl_b32 s86, s4, 2
  s_add_u32 s86, s86, s6
  s_cmp_eq_u32 s3, 0
  s_cbranch_scc1 QX_1
  s_lshl_b32 s80, s6, 7
  s_add_u32 s80, s80, s47
  s_add_u32 s80, s80, 2048
  s_sub_u32 s46, s46, 1
  s_mov_b32 s99, 0
POLL_3:
  buffer_load_dword v16, v10, s[28:31], s80 offen sc1
  s_add_u32 s99, s99, 1
  s_cmp_gt_u32 s99, 100000
  s_cbranch_scc1 L_BAIL
  s_waitcnt vmcnt(0)
  v_cmp_gt_u32 vcc, s46, v16
  s_cbranch_vccnz POLL_3
POLLOK_4:
  s_add_u32 s46, s46, 1
  s_lshl_b32 s85, s86, 15
  s_add_u32 s85, s85, 4194304
  buffer_load_dwordx4 v[128:131], v1, s[28:31], s85 offen offset:0 sc1
  buffer_load_dwordx4 v[132:135], v1, s[28:31], s85 offen offset:1024 sc1
  buffer_load_dwordx4 v[136:139], v1, s[28:31], s85 offen offset:2048 sc1
  buffer_load_dwordx4 v[140:143], v1, s[28:31], s85 offen offset:3072 sc1
  s_add_u32 s85, s85, 4096
  buffer_load_dwordx4 v[144:147], v1, s[28:31], s85 offen offset:0 sc1
  buffer_load_dwordx4 v[148:151], v1, s[28:31], s85 offen offset:1024 sc1
  buffer_load_dwordx4 v[152:155], v1, s[28:31], s85 offen offset:2048 sc1
  buffer_load_dwordx4 v[156:159], v1, s[28:31], s85 offen offset:3072 sc1
  s_add_u32 s85, s85, 4096
  buffer_load_dwordx4 v[160:163], v1, s[28:31], s85 offen offset:0 sc1
  buffer_load_dwordx4 v[164:167], v1, s[28:31], s85 offen offset:1024 sc1
  buffer_load_dwordx4 v[168:171], v1, s[28:31], s85 offen offset:2048 sc1
  buffer_load_dwordx4 v[172:175], v1, s[28:31], s85 offen offset:3072 sc1
  s_add_u32 s85, s85, 4096
  s_lshl_b32 s84, s86, 12
  s_add_u32 s84, s84, 786432
  s_mov_b64 vcc, 0
  s_branch QLD_2
QX_1:
  v_lshrrev_b32 v16, 3, v0
  v_lshlrev_b32 v17, 10, v16
  v_and_b32 v18, 7, v0
  v_lshlrev_b32 v19, 4, v18
  v_add_u32 v20, v17, v19
  s_lshl_b32 s80, s86, 15
  s_add_u32 s81, s80, 8192
  s_add_u32 s82, s80, 16384
  s_add_u32 s83, s80, 24576
  buffer_load_dwordx4 v[128:131], v20, s[8:11], s80 offen offset:0
  buffer_load_dwordx4 v[132:135], v20, s[8:11], s81 offen offset:0
  buffer_load_dwordx4 v[136:139], v20, s[8:11], s82 offen offset:0
  buffer_load_dwordx4 v[140:143], v20, s[8:11], s83 offen offset:0
  buffer_load_dwordx4 v[144:147], v20, s[8:11], s80 offen offset:128
  buffer_load_dwordx4 v[148:151], v20, s[8:11], s81 offen offset:128
  buffer_load_dwordx4 v[152:155], v20, s[8:11], s82 offen offset:128
  buffer_load_dwordx4 v[156:159], v20, s[8:11], s83 offen offset:128
  buffer_load_dwordx4 v[160:163], v20, s[8:11], s80 offen offset:256
  buffer_load_dwordx4 v[164:167], v20, s[8:11], s81 offen offset:256
  buffer_load_dwordx4 v[168:171], v20, s[8:11], s82 offen offset:256
  buffer_load_dwordx4 v[172:175], v20, s[8:11], s83 offen offset:256
  buffer_load_dwordx4 v[176:179], v20, s[8:11], s80 offen offset:384
  buffer_load_dwordx4 v[180:183], v20, s[8:11], s81 offen offset:384
  buffer_load_dwordx4 v[184:187], v20, s[8:11], s82 offen offset:384
  buffer_load_dwordx4 v[188:191], v20, s[8:11], s83 offen offset:384
  buffer_load_dwordx4 v[192:195], v20, s[8:11], s80 offen offset:512
  buffer_load_dwordx4 v[196:199], v20, s[8:11], s81 offen offset:512
  buffer_load_dwordx4 v[200:203], v20, s[8:11], s82 offen offset:512
  buffer_load_dwordx4 v[204:207], v20, s[8:11], s83 offen offset:512
  buffer_load_dwordx4 v[208:211], v20, s[8:11], s80 offen offset:640
  buffer_load_dwordx4 v[212:215], v20, s[8:11], s81 offen offset:640
  buffer_load_dwordx4 v[216:219], v20, s[8:11], s82 offen offset:640
  buffer_load_dwordx4 v[220:223], v20, s[8:11], s83 offen offset:640
  buffer_load_dwordx4 v[224:227], v20, s[8:11], s80 offen offset:768
  buffer_load_dwordx4 v[228:231], v20, s[8:11], s81 offen offset:768
  buffer_load_dwordx4 v[232:235], v20, s[8:11], s82 offen offset:768
  buffer_load_dwordx4 v[236:239], v20, s[8:11], s83 offen offset:768
  buffer_load_dwordx4 v[240:243], v20, s[8:11], s80 offen offset:896
  buffer_load_dwordx4 v[244:247], v20, s[8:11], s81 offen offset:896
  buffer_load_dwordx4 v[248:251], v20, s[8:11], s82 offen offset:896
  buffer_load_dwordx4 v[252:255], v20, s[8:11], s83 offen offset:896
  v_lshrrev_b32 v17, 4, v0
  v_xor_b32 v17, v17, v18
  v_lshlrev_b32 v17, 4, v17
  v_lshlrev_b32 v16, 7, v16
  v_add_u32 v16, v16, v17
  s_lshl_b32 s80, s6, 12
  s_add_u32 s80, s80, 98304
  v_add_u32 v21, s80, v16
  v_xor_b32 v22, 64, v21
  v_and_b32 v16, 31, v0
  v_lshrrev_b32 v17, 1, v16
  v_and_b32 v17, 7, v17
  v_lshrrev_b32 v18, 5, v0
  v_xor_b32 v17, v17, v18
  v_lshlrev_b32 v17, 4, v17
  v_lshlrev_b32 v16, 7, v16
  v_add_u32 v16, v16, v17
  v_add_u32 v23, s80, v16
  v_xor_b32 v24, 32, v23
  v_xor_b32 v25, 64, v23
  v_xor_b32 v26, 96, v23
  v_mov_b32 v16, 0
  v_mov_b32 v17, 0
  v_mov_b32 v18, 0
  v_mov_b32 v19, 0
  s_waitcnt vmcnt(28)
  ds_write_b128 v21, v[128:131] offset:0
  ds_write_b128 v22, v[132:135] offset:1024
  ds_write_b128 v21, v[136:139] offset:2048
  ds_write_b128 v22, v[140:143] offset:3072
  ds_read_b128 v[128:131], v23
  ds_read_b128 v[132:135], v24
  ds_read_b128 v[136:139], v25
  ds_read_b128 v[140:143], v26
  s_waitcnt vmcnt(24)
  ds_write_b128 v21, v[144:147] offset:0
  ds_write_b128 v22, v[148:151] offset:1024
  ds_write_b128 v21, v[152:155] offset:2048
  ds_write_b128 v22, v[156:159] offset:3072
  ds_read_b128 v[144:147], v23
  ds_read_b128 v[148:151], v24
  ds_read_b128 v[152:155], v25
  ds_read_b128 v[156:159], v26
  s_waitcnt lgkmcnt(8)
  v_dot2c_f32_bf16 v16, s100, v128
  v_dot2c_f32_bf16 v18, v128, v128
  v_dot2c_f32_bf16 v17, s100, v129
  v_dot2c_f32_bf16 v19, v129, v129
  v_dot2c_f32_bf16 v16, s100, v130
  v_dot2c_f32_bf16 v18, v130, v130
  v_dot2c_f32_bf16 v17, s100, v131
  v_dot2c_f32_bf16 v19, v131, v131
  v_dot2c_f32_bf16 v16, s100, v132
  v_dot2c_f32_bf16 v18, v132, v132
  v_dot2c_f32_bf16 v17, s100, v133
  v_dot2c_f32_bf16 v19, v133, v133
  v_dot2c_f32_bf16 v16, s100, v134
  v_dot2c_f32_bf16 v18, v134, v134
  v_dot2c_f32_bf16 v17, s100, v135
  v_dot2c_f32_bf16 v19, v135, v135
  v_dot2c_f32_bf16 v16, s100, v136
  v_dot2c_f32_bf16 v18, v136, v136
  v_dot2c_f32_bf16 v17, s100, v137
  v_dot2c_f32_bf16 v19, v137, v137
  v_dot2c_f32_bf16 v16, s100, v138
  v_dot2c_f32_bf16 v18, v138, v138
  v_dot2c_f32_bf16 v17, s100, v139
  v_dot2c_f32_bf16 v19, v139, v139
  v_dot2c_f32_bf16 v16, s100, v140
  v_dot2c_f32_bf16 v18, v140, v140
  v_dot2c_f32_bf16 v17, s100, v141
  v_dot2c_f32_bf16 v19, v141, v141
  v_dot2c_f32_bf16 v16, s100, v142
  v_dot2c_f32_bf16 v18, v142, v142
  v_dot2c_f32_bf16 v17, s100, v143
  v_dot2c_f32_bf16 v19, v143, v143
  s_waitcnt vmcnt(20)
  ds_write_b128 v21, v[160:163] offset:0
  ds_write_b128 v22, v[164:167] offset:1024
  ds_write_b128 v21, v[168:171] offset:2048
  ds_write_b128 v22, v[172:175] offset:3072
  ds_read_b128 v[160:163], v23
  ds_read_b128 v[164:167], v24
  ds_read_b128 v[168:171], v25
  ds_read_b128 v[172:175], v26
  s_waitcnt lgkmcnt(8)
  v_dot2c_f32_bf16 v16, s100, v144
  v_dot2c_f32_bf16 v18, v144, v144
  v_dot2c_f32_bf16 v17, s100, v145
  v_dot2c_f32_bf16 v19, v145, v145
  v_dot2c_f32_bf16 v16, s100, v146
  v_dot2c_f32_bf16 v18, v146, v146
  v_dot2c_f32_bf16 v17, s100, v147
  v_dot2c_f32_bf16 v19, v147, v147
  v_dot2c_f32_bf16 v16, s100, v148
  v_dot2c_f32_bf16 v18, v148, v148
  v_dot2c_f32_bf16 v17, s100, v149
  v_dot2c_f32_bf16 v19, v149, v149
  v_dot2c_f32_bf16 v16, s100, v150
  v_dot2c_f32_bf16 v18, v150, v150
  v_dot2c_f32_bf16 v17, s100, v151
  v_dot2c_f32_bf16 v19, v151, v151
  v_dot2c_f32_bf16 v16, s100, v152
  v_dot2c_f32_bf16 v18, v152, v152
  v_dot2c_f32_bf16 v17, s100, v153
  v_dot2c_f32_bf16 v19, v153, v153
  v_dot2c_f32_bf16 v16, s100, v154
  v_dot2c_f32_bf16 v18, v154, v154
  v_dot2c_f32_bf16 v17, s100, v155
  v_dot2c_f32_bf16 v19, v155, v155
  v_dot2c_f32_bf16 v16, s100, v156
  v_dot2c_f32_bf16 v18, v156, v156
  v_dot2c_f32_bf16 v17, s100, v157
  v_dot2c_f32_bf16 v19, v157, v157
  v_dot2c_f32_bf16 v16, s100, v158
  v_dot2c_f32_bf16 v18, v158, v158
  v_dot2c_f32_bf16 v17, s100, v159
  v_dot2c_f32_bf16 v19, v159, v159
  s_waitcnt vmcnt(16)
  ds_write_b128 v21, v[176:179] offset:0
  ds_write_b128 v22, v[180:183] offset:1024
  ds_write_b128 v21, v[184:187] offset:2048
  ds_write_b128 v22, v[188:191] offset:3072
  ds_read_b128 v[176:179], v23
  ds_read_b128 v[180:183], v24
  ds_read_b128 v[184:187], v25
  ds_read_b128 v[188:191], v26
  s_waitcnt lgkmcnt(8)
  v_dot2c_f32_bf16 v16, s100, v160
  v_dot2c_f32_bf16 v18, v160, v160
  v_dot2c_f32_bf16 v17, s100, v161
  v_dot2c_f32_bf16 v19, v161, v161
  v_dot2c_f32_bf16 v16, s100, v162
  v_dot2c_f32_bf16 v18, v162, v162
  v_dot2c_f32_bf16 v17, s100, v163
  v_dot2c_f32_bf16 v19, v163, v163
  v_dot2c_f32_bf16 v16, s100, v164
  v_dot2c_f32_bf16 v18, v164, v164
  v_dot2c_f32_bf16 v17, s100, v165
  v_dot2c_f32_bf16 v19, v165, v165
  v_dot2c_f32_bf16 v16, s100, v166
  v_dot2c_f32_bf16 v18, v166, v166
  v_dot2c_f32_bf16 v17, s100, v167
  v_dot2c_f32_bf16 v19, v167, v167
  v_dot2c_f32_bf16 v16, s100, v168
  v_dot2c_f32_bf16 v18, v168, v168
  v_dot2c_f32_bf16 v17, s100, v169
  v_dot2c_f32_bf16 v19, v169, v169
  v_dot2c_f32_bf16 v16, s100, v170
  v_dot2c_f32_bf16 v18, v170, v170
  v_dot2c_f32_bf16 v17, s100, v171
  v_dot2c_f32_bf16 v19, v171, v171
  v_dot2c_f32_bf16 v16, s100, v172
  v_dot2c_f32_bf16 v18, v172, v172
  v_dot2c_f32_bf16 v17, s100, v173
  v_dot2c_f32_bf16 v19, v173, v173
  v_dot2c_f32_bf16 v16, s100, v174
  v_dot2c_f32_bf16 v18, v174, v174
  v_dot2c_f32_bf16 v17, s100, v175
  v_dot2c_f32_bf16 v19, v175, v175
  s_waitcnt vmcnt(12)
  ds_write_b128 v21, v[192:195] offset:0
  ds_write_b128 v22, v[196:199] offset:1024
  ds_write_b128 v21, v[200:203] offset:2048
  ds_write_b128 v22, v[204:207] offset:3072
  ds_read_b128 v[192:195], v23
  ds_read_b128 v[196:199], v24
  ds_read_b128 v[200:203], v25
  ds_read_b128 v[204:207], v26
  s_waitcnt lgkmcnt(8)
  v_dot2c_f32_bf16 v16, s100, v176
  v_dot2c_f32_bf16 v18, v176, v176
  v_dot2c_f32_bf16 v17, s100, v177
  v_dot2c_f32_bf16 v19, v177, v177
  v_dot2c_f32_bf16 v16, s100, v178
  v_dot2c_f32_bf16 v18, v178, v178
  v_dot2c_f32_bf16 v17, s100, v179
  v_dot2c_f32_bf16 v19, v179, v179
  v_dot2c_f32_bf16 v16, s100, v180
  v_dot2c_f32_bf16 v18, v180, v180
  v_dot2c_f32_bf16 v17, s100, v181
  v_dot2c_f32_bf16 v19, v181, v181
  v_dot2c_f32_bf16 v16, s100, v182
  v_dot2c_f32_bf16 v18, v182, v182
  v_dot2c_f32_bf16 v17, s100, v183
  v_dot2c_f32_bf16 v19, v183, v183
  v_dot2c_f32_bf16 v16, s100, v184
  v_dot2c_f32_bf16 v18, v184, v184
  v_dot2c_f32_bf16 v17, s100, v185
  v_dot2c_f32_bf16 v19, v185, v185
  v_dot2c_f32_bf16 v16, s100, v186
  v_dot2c_f32_bf16 v18, v186, v186
  v_dot2c_f32_bf16 v17, s100, v187
  v_dot2c_f32_bf16 v19, v187, v187
  v_dot2c_f32_bf16 v16, s100, v188
  v_dot2c_f32_bf16 v18, v188, v188
  v_dot2c_f32_bf16 v17, s100, v189
  v_dot2c_f32_bf16 v19, v189, v189
  v_dot2c_f32_bf16 v16, s100, v190
  v_dot2c_f32_bf16 v18, v190, v190
  v_dot2c_f32_bf16 v17, s100, v191
  v_dot2c_f32_bf16 v19, v191, v191
  s_waitcnt vmcnt(8)
  ds_write_b128 v21, v[208:211] offset:0
  ds_write_b128 v22, v[212:215] offset:1024
  ds_write_b128 v21, v[216:219] offset:2048
  ds_write_b128 v22, v[220:223] offset:3072
  ds_read_b128 v[208:211], v23
  ds_read_b128 v[212:215], v24
  ds_read_b128 v[216:219], v25
  ds_read_b128 v[220:223], v26
  s_waitcnt lgkmcnt(8)
  v_dot2c_f32_bf16 v16, s100, v192
  v_dot2c_f32_bf16 v18, v192, v192
  v_dot2c_f32_bf16 v17, s100, v193
  v_dot2c_f32_bf16 v19, v193, v193
  v_dot2c_f32_bf16 v16, s100, v194
  v_dot2c_f32_bf16 v18, v194, v194
  v_dot2c_f32_bf16 v17, s100, v195
  v_dot2c_f32_bf16 v19, v195, v195
  v_dot2c_f32_bf16 v16, s100, v196
  v_dot2c_f32_bf16 v18, v196, v196
  v_dot2c_f32_bf16 v17, s100, v197
  v_dot2c_f32_bf16 v19, v197, v197
  v_dot2c_f32_bf16 v16, s100, v198
  v_dot2c_f32_bf16 v18, v198, v198
  v_dot2c_f32_bf16 v17, s100, v199
  v_dot2c_f32_bf16 v19, v199, v199
  v_dot2c_f32_bf16 v16, s100, v200
  v_dot2c_f32_bf16 v18, v200, v200
  v_dot2c_f32_bf16 v17, s100, v201
  v_dot2c_f32_bf16 v19, v201, v201
  v_dot2c_f32_bf16 v16, s100, v202
  v_dot2c_f32_bf16 v18, v202, v202
  v_dot2c_f32_bf16 v17, s100, v203
  v_dot2c_f32_bf16 v19, v203, v203
  v_dot2c_f32_bf16 v16, s100, v204
  v_dot2c_f32_bf16 v18, v204, v204
  v_dot2c_f32_bf16 v17, s100, v205
  v_dot2c_f32_bf16 v19, v205, v205
  v_dot2c_f32_bf16 v16, s100, v206
  v_dot2c_f32_bf16 v18, v206, v206
  v_dot2c_f32_bf16 v17, s100, v207
  v_dot2c_f32_bf16 v19, v207, v207
  s_waitcnt vmcnt(4)
  ds_write_b128 v21, v[224:227] offset:0
  ds_write_b128 v22, v[228:231] offset:1024
  ds_write_b128 v21, v[232:235] offset:2048
  ds_write_b128 v22, v[236:239] offset:3072
  ds_read_b128 v[224:227], v23
  ds_read_b128 v[228:231], v24
  ds_read_b128 v[232:235], v25
  ds_read_b128 v[236:239], v26
  s_waitcnt lgkmcnt(8)
  v_dot2c_f32_bf16 v16, s100, v208
  v_dot2c_f32_bf16 v18, v208, v208
  v_dot2c_f32_bf16 v17, s100, v209
  v_dot2c_f32_bf16 v19, v209, v209
  v_dot2c_f32_bf16 v16, s100, v210
  v_dot2c_f32_bf16 v18, v210, v210
  v_dot2c_f32_bf16 v17, s100, v211
  v_dot2c_f32_bf16 v19, v211, v211
  v_dot2c_f32_bf16 v16, s100, v212
  v_dot2c_f32_bf16 v18, v212, v212
  v_dot2c_f32_bf16 v17, s100, v213
  v_dot2c_f32_bf16 v19, v213, v213
  v_dot2c_f32_bf16 v16, s100, v214
  v_dot2c_f32_bf16 v18, v214, v214
  v_dot2c_f32_bf16 v17, s100, v215
  v_dot2c_f32_bf16 v19, v215, v215
  v_dot2c_f32_bf16 v16, s100, v216
  v_dot2c_f32_bf16 v18, v216, v216
  v_dot2c_f32_bf16 v17, s100, v217
  v_dot2c_f32_bf16 v19, v217, v217
  v_dot2c_f32_bf16 v16, s100, v218
  v_dot2c_f32_bf16 v18, v218, v218
  v_dot2c_f32_bf16 v17, s100, v219
  v_dot2c_f32_bf16 v19, v219, v219
  v_dot2c_f32_bf16 v16, s100, v220
  v_dot2c_f32_bf16 v18, v220, v220
  v_dot2c_f32_bf16 v17, s100, v221
  v_dot2c_f32_bf16 v19, v221, v221
  v_dot2c_f32_bf16 v16, s100, v222
  v_dot2c_f32_bf16 v18, v222, v222
  v_dot2c_f32_bf16 v17, s100, v223
  v_dot2c_f32_bf16 v19, v223, v223
  s_waitcnt vmcnt(0)
  ds_write_b128 v21, v[240:243] offset:0
  ds_write_b128 v22, v[244:247] offset:1024
  ds_write_b128 v21, v[248:251] offset:2048
  ds_write_b128 v22, v[252:255] offset:3072
  ds_read_b128 v[240:243], v23
  ds_read_b128 v[244:247], v24
  ds_read_b128 v[248:251], v25
  ds_read_b128 v[252:255], v26
  s_waitcnt lgkmcnt(8)
  v_dot2c_f32_bf16 v16, s100, v224
  v_dot2c_f32_bf16 v18, v224, v224
  v_dot2c_f32_bf16 v17, s100, v225
  v_dot2c_f32_bf16 v19, v225, v225
  v_dot2c_f32_bf16 v16, s100, v226
  v_dot2c_f32_bf16 v18, v226, v226
  v_dot2c_f32_bf16 v17, s100, v227
  v_dot2c_f32_bf16 v19, v227, v227
  v_dot2c_f32_bf16 v16, s100, v228
  v_dot2c_f32_bf16 v18, v228, v228
  v_dot2c_f32_bf16 v17, s100, v229
  v_dot2c_f32_bf16 v19, v229, v229
  v_dot2c_f32_bf16 v16, s100, v230
  v_dot2c_f32_bf16 v18, v230, v230
  v_dot2c_f32_bf16 v17, s100, v231
  v_dot2c_f32_bf16 v19, v231, v231
  v_dot2c_f32_bf16 v16, s100, v232
  v_dot2c_f32_bf16 v18, v232, v232
  v_dot2c_f32_bf16 v17, s100, v233
  v_dot2c_f32_bf16 v19, v233, v233
  v_dot2c_f32_bf16 v16, s100, v234
  v_dot2c_f32_bf16 v18, v234, v234
  v_dot2c_f32_bf16 v17, s100, v235
  v_dot2c_f32_bf16 v19, v235, v235
  v_dot2c_f32_bf16 v16, s100, v236
  v_dot2c_f32_bf16 v18, v236, v236
  v_dot2c_f32_bf16 v17, s100, v237
  v_dot2c_f32_bf16 v19, v237, v237
  v_dot2c_f32_bf16 v16, s100, v238
  v_dot2c_f32_bf16 v18, v238, v238
  v_dot2c_f32_bf16 v17, s100, v239
  v_dot2c_f32_bf16 v19, v239, v239
  s_waitcnt lgkmcnt(0)
  v_dot2c_f32_bf16 v16, s100, v240
  v_dot2c_f32_bf16 v18, v240, v240
  v_dot2c_f32_bf16 v17, s100, v241
  v_dot2c_f32_bf16 v19, v241, v241
  v_dot2c_f32_bf16 v16, s100, v242
  v_dot2c_f32_bf16 v18, v242, v242
  v_dot2c_f32_bf16 v17, s100, v243
  v_dot2c_f32_bf16 v19, v243, v243
  v_dot2c_f32_bf16 v16, s100, v244
  v_dot2c_f32_bf16 v18, v244, v244
  v_dot2c_f32_bf16 v17, s100, v245
  v_dot2c_f32_bf16 v19, v245, v245
  v_dot2c_f32_bf16 v16, s100, v246
  v_dot2c_f32_bf16 v18, v246, v246
  v_dot2c_f32_bf16 v17, s100, v247
  v_dot2c_f32_bf16 v19, v247, v247
  v_dot2c_f32_bf16 v16, s100, v248
  v_dot2c_f32_bf16 v18, v248, v248
  v_dot2c_f32_bf16 v17, s100, v249
  v_dot2c_f32_bf16 v19, v249, v249
  v_dot2c_f32_bf16 v16, s100, v250
  v_dot2c_f32_bf16 v18, v250, v250
  v_dot2c_f32_bf16 v17, s100, v251
  v_dot2c_f32_bf16 v19, v251, v251
  v_dot2c_f32_bf16 v16, s100, v252
  v_dot2c_f32_bf16 v18, v252, v252
  v_dot2c_f32_bf16 v17, s100, v253
  v_dot2c_f32_bf16 v19, v253, v253
  v_dot2c_f32_bf16 v16, s100, v254
  v_dot2c_f32_bf16 v18, v254, v254
  v_dot2c_f32_bf16 v17, s100, v255
  v_dot2c_f32_bf16 v19, v255, v255
  s_mov_b64 vcc, -1
QLD_2:
  s_barrier
  ds_read_b64_tr_b16 v[48:49], v12 offset:0
  ds_read_b64_tr_b16 v[50:51], v13 offset:0
  ds_read_b64_tr_b16 v[52:53], v12 offset:32768
  ds_read_b64_tr_b16 v[54:55], v13 offset:32768
  ds_read_b64_tr_b16 v[56:57], v12 offset:1024
  ds_read_b64_tr_b16 v[58:59], v13 offset:1024
  ds_read_b64_tr_b16 v[60:61], v12 offset:33792
  ds_read_b64_tr_b16 v[62:63], v13 offset:33792
  ds_read_b64_tr_b16 v[64:65], v12 offset:2048
  ds_read_b64_tr_b16 v[66:67], v13 offset:2048
  ds_read_b64_tr_b16 v[68:69], v12 offset:34816
  ds_read_b64_tr_b16 v[70:71], v13 offset:34816
  s_waitcnt vmcnt(11) lgkmcnt(8)
  v_mfma_f32_32x32x16_bf16 v[80:95], v[48:51], v[128:131], 0
  ds_read_b64_tr_b16 v[72:73], v12 offset:3072
  ds_read_b64_tr_b16 v[74:75], v13 offset:3072
  ds_read_b64_tr_b16 v[76:77], v12 offset:35840
  ds_read_b64_tr_b16 v[78:79], v13 offset:35840
  v_mfma_f32_32x32x16_bf16 v[96:111], v[52:55], v[128:131], 0
  s_cbranch_vccnz DOTB_5
  buffer_load_dwordx4 v[176:179], v1, s[28:31], s85 offen offset:0 sc1
DOTB_5:
  s_waitcnt vmcnt(11) lgkmcnt(8)
  v_mfma_f32_32x32x16_bf16 v[80:95], v[56:59], v[132:135], v[80:95]
  ds_read_b64_tr_b16 v[48:49], v12 offset:4096
  ds_read_b64_tr_b16 v[50:51], v13 offset:4096
  ds_read_b64_tr_b16 v[52:53], v12 offset:36864
  ds_read_b64_tr_b16 v[54:55], v13 offset:36864
  v_mfma_f32_32x32x16_bf16 v[96:111], v[60:63], v[132:135], v[96:111]
  s_cbranch_vccnz DOTB_6
  buffer_load_dwordx4 v[180:183], v1, s[28:31], s85 offen offset:1024 sc1
DOTB_6:
  s_waitcnt vmcnt(11) lgkmcnt(8)
  v_mfma_f32_32x32x16_bf16 v[80:95], v[64:67], v[136:139], v[80:95]
  ds_read_b64_tr_b16 v[56:57], v12 offset:5120
  ds_read_b64_tr_b16 v[58:59], v13 offset:5120
  ds_read_b64_tr_b16 v[60:61], v12 offset:37888
  ds_read_b64_tr_b16 v[62:63], v13 offset:37888
  v_mfma_f32_32x32x16_bf16 v[96:111], v[68:71], v[136:139], v[96:111]
  s_cbranch_vccnz DOTB_7
  buffer_load_dwordx4 v[184:187], v1, s[28:31], s85 offen offset:2048 sc1
DOTB_7:
  s_waitcnt vmcnt(11) lgkmcnt(8)
  v_mfma_f32_32x32x16_bf16 v[80:95], v[72:75], v[140:143], v[80:95]
  ds_read_b64_tr_b16 v[64:65], v12 offset:6144
  ds_read_b64_tr_b16 v[66:67], v13 offset:6144
  ds_read_b64_tr_b16 v[68:69], v12 offset:38912
  ds_read_b64_tr_b16 v[70:71], v13 offset:38912
  v_mfma_f32_32x32x16_bf16 v[96:111], v[76:79], v[140:143], v[96:111]
  s_cbranch_vccnz DOTB_8
  buffer_load_dwordx4 v[188:191], v1, s[28:31], s85 offen offset:3072 sc1
  s_add_u32 s85, s85, 4096
DOTB_8:
  s_waitcnt vmcnt(11) lgkmcnt(8)
  v_mfma_f32_32x32x16_bf16 v[80:95], v[48:51], v[144:147], v[80:95]
  ds_read_b64_tr_b16 v[72:73], v12 offset:7168
  ds_read_b64_tr_b16 v[74:75], v13 offset:7168
  ds_read_b64_tr_b16 v[76:77], v12 offset:39936
  ds_read_b64_tr_b16 v[78:79], v13 offset:39936
  v_mfma_f32_32x32x16_bf16 v[96:111], v[52:55], v[144:147], v[96:111]
  s_cbranch_vccnz DOTB_9
  buffer_load_dwordx4 v[192:195], v1, s[28:31], s85 offen offset:0 sc1
DOTB_9:
  s_barrier
  s_waitcnt vmcnt(11) lgkmcnt(8)
  v_mfma_f32_32x32x16_bf16 v[80:95], v[56:59], v[148:151], v[80:95]
  ds_read_b64_tr_b16 v[48:49], v12 offset:8192
  ds_read_b64_tr_b16 v[50:51], v13 offset:8192
  ds_read_b64_tr_b16 v[52:53], v12 offset:40960
  ds_read_b64_tr_b16 v[54:55], v13 offset:40960
  v_mfma_f32_32x32x16_bf16 v[96:111], v[60:63], v[148:151], v[96:111]
  s_cbranch_vccnz DOTB_10
  buffer_load_dwordx4 v[196:199], v1, s[28:31], s85 offen offset:1024 sc1
DOTB_10:
  s_waitcnt vmcnt(11) lgkmcnt(8)
  v_mfma_f32_32x32x16_bf16 v[80:95], v[64:67], v[152:155], v[80:95]
  ds_read_b64_tr_b16 v[56:57], v12 offset:9216
  ds_read_b64_tr_b16 v[58:59], v13 offset:9216
  ds_read_b64_tr_b16 v[60:61], v12 offset:41984
  ds_read_b64_tr_b16 v[62:63], v13 offset:41984
  v_mfma_f32_32x32x16_bf16 v[96:111], v[68:71], v[152:155], v[96:111]
  s_cbranch_vccnz DOTB_11
  buffer_load_dwordx4 v[200:203], v1, s[28:31], s85 offen offset:2048 sc1
DOTB_11:
  s_waitcnt vmcnt(11) lgkmcnt(8)
  v_mfma_f32_32x32x16_bf16 v[80:95], v[72:75], v[156:159], v[80:95]
  ds_read_b64_tr_b16 v[64:65], v12 offset:10240
  ds_read_b64_tr_b16 v[66:67], v13 offset:10240
  ds_read_b64_tr_b16 v[68:69], v12 offset:43008
  ds_read_b64_tr_b16 v[70:71], v13 offset:43008
  v_mfma_f32_32x32x16_bf16 v[96:111], v[76:79], v[156:159], v[96:111]
  s_cbranch_vccnz DOTB_12
  buffer_load_dwordx4 v[204:207], v1, s[28:31], s85 offen offset:3072 sc1
  s_add_u32 s85, s85, 4096
DOTB_12:
  s_waitcnt vmcnt(11) lgkmcnt(8)
  v_mfma_f32_32x32x16_bf16 v[80:95], v[48:51], v[160:163], v[80:95]
  ds_read_b64_tr_b16 v[72:73], v12 offset:11264
  ds_read_b64_tr_b16 v[74:75], v13 offset:11264
  ds_read_b64_tr_b16 v[76:77], v12 offset:44032
  ds_read_b64_tr_b16 v[78:79], v13 offset:44032
  v_mfma_f32_32x32x16_bf16 v[96:111], v[52:55], v[160:163], v[96:111]
  s_cbranch_vccnz DOTB_13
  buffer_load_dwordx4 v[208:211], v1, s[28:31], s85 offen offset:0 sc1
DOTB_13:
  s_waitcnt vmcnt(11) lgkmcnt(8)
  v_mfma_f32_32x32x16_bf16 v[80:95], v[56:59], v[164:167], v[80:95]
  ds_read_b64_tr_b16 v[48:49], v12 offset:12288
  ds_read_b64_tr_b16 v[50:51], v13 offset:12288
  ds_read_b64_tr_b16 v[52:53], v12 offset:45056
  ds_read_b64_tr_b16 v[54:55], v13 offset:45056
  v_mfma_f32_32x32x16_bf16 v[96:111], v[60:63], v[164:167], v[96:111]
  s_cbranch_vccnz DOTB_14
  buffer_load_dwordx4 v[212:215], v1, s[28:31], s85 offen offset:1024 sc1
DOTB_14:
  s_waitcnt vmcnt(11) lgkmcnt(8)
  v_mfma_f32_32x32x16_bf16 v[80:95], v[64:67], v[168:171], v[80:95]
  ds_read_b64_tr_b16 v[56:57], v12 offset:13312
  ds_read_b64_tr_b16 v[58:59], v13 offset:13312
  ds_read_b64_tr_b16 v[60:61], v12 offset:46080
  ds_read_b64_tr_b16 v[62:63], v13 offset:46080
  v_mfma_f32_32x32x16_bf16 v[96:111], v[68:71], v[168:171], v[96:111]
  s_cbranch_vccnz DOTB_15
  buffer_load_dwordx4 v[216:219], v1, s[28:31], s85 offen offset:2048 sc1
DOTB_15:
  s_waitcnt vmcnt(11) lgkmcnt(8)
  v_mfma_f32_32x32x16_bf16 v[80:95], v[72:75], v[172:175], v[80:95]
  ds_read_b64_tr_b16 v[64:65], v12 offset:14336
  ds_read_b64_tr_b16 v[66:67], v13 offset:14336
  ds_read_b64_tr_b16 v[68:69], v12 offset:47104
  ds_read_b64_tr_b16 v[70:71], v13 offset:47104
  v_mfma_f32_32x32x16_bf16 v[96:111], v[76:79], v[172:175], v[96:111]
  s_cbranch_vccnz DOTB_16
  buffer_load_dwordx4 v[220:223], v1, s[28:31], s85 offen offset:3072 sc1
  s_add_u32 s85, s85, 4096
DOTB_16:
  s_waitcnt vmcnt(11) lgkmcnt(8)
  v_mfma_f32_32x32x16_bf16 v[80:95], v[48:51], v[176:179], v[80:95]
  ds_read_b64_tr_b16 v[72:73], v12 offset:15360
  ds_read_b64_tr_b16 v[74:75], v13 offset:15360
  ds_read_b64_tr_b16 v[76:77], v12 offset:48128
  ds_read_b64_tr_b16 v[78:79], v13 offset:48128
  v_mfma_f32_32x32x16_bf16 v[96:111], v[52:55], v[176:179], v[96:111]
  s_cbranch_vccnz DOTB_17
  buffer_load_dwordx4 v[224:227], v1, s[28:31], s85 offen offset:0 sc1
  buffer_load_dwordx4 v[16:19], v1, s[28:31], s84 offen offset:0 sc1
  buffer_load_dwordx4 v[20:23], v1, s[28:31], s84 offen offset:1024 sc1
  buffer_load_dwordx4 v[24:27], v1, s[28:31], s84 offen offset:2048 sc1
  buffer_load_dwordx4 v[28:31], v1, s[28:31], s84 offen offset:3072 sc1
DOTB_17:
  s_barrier
  s_waitcnt vmcnt(15) lgkmcnt(8)
  v_mfma_f32_32x32x16_bf16 v[80:95], v[56:59], v[180:183], v[80:95]
  ds_read_b64_tr_b16 v[48:49], v12 offset:16384
  ds_read_b64_tr_b16 v[50:51], v13 offset:16384
  ds_read_b64_tr_b16 v[52:53], v12 offset:49152
  ds_read_b64_tr_b16 v[54:55], v13 offset:49152
  v_mfma_f32_32x32x16_bf16 v[96:111], v[60:63], v[180:183], v[96:111]
  s_cbranch_vccnz DOTB_18
  buffer_load_dwordx4 v[228:231], v1, s[28:31], s85 offen offset:1024 sc1
DOTB_18:
  s_waitcnt vmcnt(15) lgkmcnt(8)
  v_mfma_f32_32x32x16_bf16 v[80:95], v[64:67], v[184:187], v[80:95]
  ds_read_b64_tr_b16 v[56:57], v12 offset:17408
  ds_read_b64_tr_b16 v[58:59], v13 offset:17408
  ds_read_b64_tr_b16 v[60:61], v12 offset:50176
  ds_read_b64_tr_b16 v[62:63], v13 offset:50176
  v_mfma_f32_32x32x16_bf16 v[96:111], v[68:71], v[184:187], v[96:111]
  s_cbranch_vccnz DOTB_19
  buffer_load_dwordx4 v[232:235], v1, s[28:31], s85 offen offset:2048 sc1
DOTB_19:
  s_waitcnt vmcnt(15) lgkmcnt(8)
  v_mfma_f32_32x32x16_bf16 v[80:95], v[72:75], v[188:191], v[80:95]
  ds_read_b64_tr_b16 v[64:65], v12 offset:18432
  ds_read_b64_tr_b16 v[66:67], v13 offset:18432
  ds_read_b64_tr_b16 v[68:69], v12 offset:51200
  ds_read_b64_tr_b16 v[70:71], v13 offset:51200
  v_mfma_f32_32x32x16_bf16 v[96:111], v[76:79], v[188:191], v[96:111]
  s_cbranch_vccnz DOTB_20
  buffer_load_dwordx4 v[236:239], v1, s[28:31], s85 offen offset:3072 sc1
  s_add_u32 s85, s85, 4096
DOTB_20:
  s_waitcnt vmcnt(15) lgkmcnt(8)
  v_mfma_f32_32x32x16_bf16 v[80:95], v[48:51], v[192:195], v[80:95]
  ds_read_b64_tr_b16 v[72:73], v12 offset:19456
  ds_read_b64_tr_b16 v[74:75], v13 offset:19456
  ds_read_b64_tr_b16 v[76:77], v12 offset:52224
  ds_read_b64_tr_b16 v[78:79], v13 offset:52224
  v_mfma_f32_32x32x16_bf16 v[96:111], v[52:55], v[192:195], v[96:111]
  s_cbranch_vccnz DOTB_21
  buffer_load_dwordx4 v[240:243], v1, s[28:31], s85 offen offset:0 sc1
DOTB_21:
  s_waitcnt vmcnt(15) lgkmcnt(8)
  v_mfma_f32_32x32x16_bf16 v[80:95], v[56:59], v[196:199], v[80:95]
  ds_read_b64_tr_b16 v[48:49], v12 offset:20480
  ds_read_b64_tr_b16 v[50:51], v13 offset:20480
  ds_read_b64_tr_b16 v[52:53], v12 offset:53248
  ds_read_b64_tr_b16 v[54:55], v13 offset:53248
  v_mfma_f32_32x32x16_bf16 v[96:111], v[60:63], v[196:199], v[96:111]
  s_cbranch_vccnz DOTB_22
  buffer_load_dwordx4 v[244:247], v1, s[28:31], s85 offen offset:1024 sc1
DOTB_22:
  s_waitcnt vmcnt(15) lgkmcnt(8)
  v_mfma_f32_32x32x16_bf16 v[80:95], v[64:67], v[200:203], v[80:95]
  ds_read_b64_tr_b16 v[56:57], v12 offset:21504
  ds_read_b64_tr_b16 v[58:59], v13 offset:21504
  ds_read_b64_tr_b16 v[60:61], v12 offset:54272
  ds_read_b64_tr_b16 v[62:63], v13 offset:54272
  v_mfma_f32_32x32x16_bf16 v[96:111], v[68:71], v[200:203], v[96:111]
  s_cbranch_vccnz DOTB_23
  buffer_load_dwordx4 v[248:251], v1, s[28:31], s85 offen offset:2048 sc1
DOTB_23:
  s_waitcnt vmcnt(15) lgkmcnt(8)
  v_mfma_f32_32x32x16_bf16 v[80:95], v[72:75], v[204:207], v[80:95]
  ds_read_b64_tr_b16 v[64:65], v12 offset:22528
  ds_read_b64_tr_b16 v[66:67], v13 offset:22528
  ds_read_b64_tr_b16 v[68:69], v12 offset:55296
  ds_read_b64_tr_b16 v[70:71], v13 offset:55296
  v_mfma_f32_32x32x16_bf16 v[96:111], v[76:79], v[204:207], v[96:111]
  s_cbranch_vccnz DOTB_24
  buffer_load_dwordx4 v[252:255], v1, s[28:31], s85 offen offset:3072 sc1
DOTB_24:
  s_waitcnt vmcnt(15) lgkmcnt(8)
  v_mfma_f32_32x32x16_bf16 v[80:95], v[48:51], v[208:211], v[80:95]
  ds_read_b64_tr_b16 v[72:73], v12 offset:23552
  ds_read_b64_tr_b16 v[74:75], v13 offset:23552
  ds_read_b64_tr_b16 v[76:77], v12 offset:56320
  ds_read_b64_tr_b16 v[78:79], v13 offset:56320
  v_mfma_f32_32x32x16_bf16 v[96:111], v[52:55], v[208:211], v[96:111]
  s_barrier
  s_waitcnt vmcnt(14) lgkmcnt(8)
  v_mfma_f32_32x32x16_bf16 v[80:95], v[56:59], v[212:215], v[80:95]
  ds_read_b64_tr_b16 v[48:49], v12 offset:24576
  ds_read_b64_tr_b16 v[50:51], v13 offset:24576
  ds_read_b64_tr_b16 v[52:53], v12 offset:57344
  ds_read_b64_tr_b16 v[54:55], v13 offset:57344
  v_mfma_f32_32x32x16_bf16 v[96:111], v[60:63], v[212:215], v[96:111]
  s_waitcnt vmcnt(13) lgkmcnt(8)
  v_mfma_f32_32x32x16_bf16 v[80:95], v[64:67], v[216:219], v[80:95]
  ds_read_b64_tr_b16 v[56:57], v12 offset:25600
  ds_read_b64_tr_b16 v[58:59], v13 offset:25600
  ds_read_b64_tr_b16 v[60:61], v12 offset:58368
  ds_read_b64_tr_b16 v[62:63], v13 offset:58368
  v_mfma_f32_32x32x16_bf16 v[96:111], v[68:71], v[216:219], v[96:111]
  s_waitcnt vmcnt(12) lgkmcnt(8)
  v_mfma_f32_32x32x16_bf16 v[80:95], v[72:75], v[220:223], v[80:95]
  ds_read_b64_tr_b16 v[64:65], v12 offset:26624
  ds_read_b64_tr_b16 v[66:67], v13 offset:26624
  ds_read_b64_tr_b16 v[68:69], v12 offset:59392
  ds_read_b64_tr_b16 v[70:71], v13 offset:59392
  v_mfma_f32_32x32x16_bf16 v[96:111], v[76:79], v[220:223], v[96:111]
  s_waitcnt vmcnt(11) lgkmcnt(8)
  v_mfma_f32_32x32x16_bf16 v[80:95], v[48:51], v[224:227], v[80:95]
  ds_read_b64_tr_b16 v[72:73], v12 offset:27648
  ds_read_b64_tr_b16 v[74:75], v13 offset:27648
  ds_read_b64_tr_b16 v[76:77], v12 offset:60416
  ds_read_b64_tr_b16 v[78:79], v13 offset:60416
  v_mfma_f32_32x32x16_bf16 v[96:111], v[52:55], v[224:227], v[96:111]
  s_waitcnt vmcnt(6) lgkmcnt(8)
  v_mfma_f32_32x32x16_bf16 v[80:95], v[56:59], v[228:231], v[80:95]
  ds_read_b64_tr_b16 v[48:49], v12 offset:28672
  ds_read_b64_tr_b16 v[50:51], v13 offset:28672
  ds_read_b64_tr_b16 v[52:53], v12 offset:61440
  ds_read_b64_tr_b16 v[54:55], v13 offset:61440
  v_mfma_f32_32x32x16_bf16 v[96:111], v[60:63], v[228:231], v[96:111]
  s_waitcnt vmcnt(5) lgkmcnt(8)
  v_mfma_f32_32x32x16_bf16 v[80:95], v[64:67], v[232:235], v[80:95]
  ds_read_b64_tr_b16 v[56:57], v12 offset:29696
  ds_read_b64_tr_b16 v[58:59], v13 offset:29696
  ds_read_b64_tr_b16 v[60:61], v12 offset:62464
  ds_read_b64_tr_b16 v[62:63], v13 offset:62464
  v_mfma_f32_32x32x16_bf16 v[96:111], v[68:71], v[232:235], v[96:111]
  s_waitcnt vmcnt(4) lgkmcnt(8)
  v_mfma_f32_32x32x16_bf16 v[80:95], v[72:75], v[236:239], v[80:95]
  ds_read_b64_tr_b16 v[64:65], v12 offset:30720
  ds_read_b64_tr_b16 v[66:67], v13 offset:30720
  ds_read_b64_tr_b16 v[68:69], v12 offset:63488
  ds_read_b64_tr_b16 v[70:71], v13 offset:63488
  v_mfma_f32_32x32x16_bf16 v[96:111], v[76:79], v[236:239], v[96:111]
  s_waitcnt vmcnt(3) lgkmcnt(8)
  v_mfma_f32_32x32x16_bf16 v[80:95], v[48:51], v[240:243], v[80:95]
  ds_read_b64_tr_b16 v[72:73], v12 offset:31744
  ds_read_b64_tr_b16 v[74:75], v13 offset:31744
  ds_read_b64_tr_b16 v[76:77], v12 offset:64512
  ds_read_b64_tr_b16 v[78:79], v13 offset:64512
  v_mfma_f32_32x32x16_bf16 v[96:111], v[52:55], v[240:243], v[96:111]
  s_waitcnt vmcnt(2) lgkmcnt(8)
  v_mfma_f32_32x32x16_bf16 v[80:95], v[56:59], v[244:247], v[80:95]
  v_mfma_f32_32x32x16_bf16 v[96:111], v[60:63], v[244:247], v[96:111]
  s_waitcnt vmcnt(1) lgkmcnt(4)
  v_mfma_f32_32x32x16_bf16 v[80:95], v[64:67], v[248:251], v[80:95]
  v_mfma_f32_32x32x16_bf16 v[96:111], v[68:71], v[248:251], v[96:111]
  s_waitcnt vmcnt(0) lgkmcnt(0)
  v_mfma_f32_32x32x16_bf16 v[80:95], v[72:75], v[252:255], v[80:95]
  v_mfma_f32_32x32x16_bf16 v[96:111], v[76:79], v[252:255], v[96:111]
  s_barrier
  ds_read_b32 v32, v44
  ds_read_b32 v36, v44 offset:128
  ds_read_b64_tr_b16 v[48:49], v14 offset:0
  ds_read_b64_tr_b16 v[50:51], v15 offset:0
  ds_read_b64_tr_b16 v[52:53], v14 offset:1024
  ds_read_b64_tr_b16 v[54:55], v15 offset:1024
  ds_read_b64_tr_b16 v[56:57], v14 offset:2048
  ds_read_b64_tr_b16 v[58:59], v15 offset:2048
  ds_read_b64_tr_b16 v[60:61], v14 offset:3072
  ds_read_b64_tr_b16 v[62:63], v15 offset:3072
  ds_read_b64_tr_b16 v[64:65], v14 offset:4096
  ds_read_b64_tr_b16 v[66:67], v15 offset:4096
  s_cmp_eq_u32 s3, 0
  s_cbranch_scc1 ST0_25
  v_pk_add_f32 v[16:17], v[16:17], v[18:19]
  v_pk_add_f32 v[20:21], v[20:21], v[22:23]
  v_pk_add_f32 v[24:25], v[24:25], v[26:27]
  v_pk_add_f32 v[28:29], v[28:29], v[30:31]
  v_pk_add_f32 v[16:17], v[16:17], v[20:21]
  v_pk_add_f32 v[24:25], v[24:25], v[28:29]
  v_pk_add_f32 v[16:17], v[16:17], v[24:25]
  s_branch ST1_26
ST0_25:
  s_nop 3
  v_add_f32 v16, v16, v17
  v_add_f32 v17, v18, v19
ST1_26:
  v_mov_b32 v20, v16
  v_mov_b32 v21, v17
  s_nop 0
  v_permlane32_swap_b32 v16, v20
  v_permlane32_swap_b32 v17, v21
  v_add_f32 v16, v16, v20
  v_add_f32 v17, v17, v21
  v_mul_f32 v16, 0x3b000000, v16
  v_mul_f32 v17, 0x3b000000, v17
  v_fma_f32 v17, -v16, v16, v17
  v_max_f32 v17, 0, v17
  v_cvt_pk_bf16_f32 v28, v16, v16
  v_cvt_pk_bf16_f32 v20, v17, v17
  v_lshlrev_b32 v20, 16, v20
  v_add_f32 v20, 0x3727c5ac, v20
  v_cvt_pk_bf16_f32 v20, v20, v20
  v_lshlrev_b32 v20, 16, v20
  v_sqrt_f32 v20, v20
  s_nop 0
  v_cvt_pk_bf16_f32 v29, v20, v20
  v_lshlrev_b32 v20, 16, v29
  v_rcp_f32 v30, v20
  v_mov_b32 v33, 0
  v_mov_b32 v34, 0
  v_mov_b32 v35, 0
  v_mov_b32 v37, 0
  v_mov_b32 v38, 0
  v_mov_b32 v39, 0
  v_mov_b32 v41, 0
  v_mov_b32 v42, 0
  v_mov_b32 v43, 0
  v_cmp_gt_u32 vcc, 32, v0
  s_nop 1
  v_cndmask_b32 v40, 0, v28, vcc
  s_waitcnt lgkmcnt(10)
  s_nop 0
  v_mfma_f32_32x32x16_bf16 v[80:95], v[32:35], v[40:43], v[80:95]
  v_mfma_f32_32x32x16_bf16 v[96:111], v[36:39], v[40:43], v[96:111]
  s_lshl_b32 s80, s6, 10
  s_add_u32 s80, s80, 106496
  v_add_u32 v45, s80, v1
  s_lshl_b32 s80, s86, 16
  s_lshl_b32 s81, s5, 12
  s_add_u32 s80, s80, s81
  s_lshl_b32 s81, s3, 22
  s_add_u32 s80, s80, s81
  s_add_u32 s80, s80, 14680064
  s_nop 1
  v_pk_mul_f32 v[80:81], v[80:81], v[30:31] op_sel_hi:[1,0]
  v_pk_mul_f32 v[82:83], v[82:83], v[30:31] op_sel_hi:[1,0]
  v_pk_mul_f32 v[84:85], v[84:85], v[30:31] op_sel_hi:[1,0]
  v_pk_mul_f32 v[86:87], v[86:87], v[30:31] op_sel_hi:[1,0]
  v_pk_mul_f32 v[88:89], v[88:89], v[30:31] op_sel_hi:[1,0]
  v_pk_mul_f32 v[90:91], v[90:91], v[30:31] op_sel_hi:[1,0]
  v_pk_mul_f32 v[92:93], v[92:93], v[30:31] op_sel_hi:[1,0]
  v_pk_mul_f32 v[94:95], v[94:95], v[30:31] op_sel_hi:[1,0]
  v_cvt_pk_bf16_f32 v68, v80, v81
  v_cvt_pk_bf16_f32 v69, v82, v83
  v_cvt_pk_bf16_f32 v70, v84, v85
  v_cvt_pk_bf16_f32 v71, v86, v87
  v_cvt_pk_bf16_f32 v72, v88, v89
  v_cvt_pk_bf16_f32 v73, v90, v91
  v_cvt_pk_bf16_f32 v74, v92, v93
  v_cvt_pk_bf16_f32 v75, v94, v95
  buffer_store_dwordx4 v[68:71], v1, s[28:31], s80 offen offset:0 sc1
  ds_write_b128 v45, v[68:71] offset:0
  buffer_store_dwordx4 v[72:75], v1, s[28:31], s80 offen offset:2048 sc1
  ds_write_b128 v45, v[72:75] offset:12288
  v_pk_mul_f32 v[96:97], v[96:97], v[30:31] op_sel_hi:[1,0]
  v_pk_mul_f32 v[98:99], v[98:99], v[30:31] op_sel_hi:[1,0]
  v_pk_mul_f32 v[100:101], v[100:101], v[30:31] op_sel_hi:[1,0]
  v_pk_mul_f32 v[102:103], v[102:103], v[30:31] op_sel_hi:[1,0]
  v_pk_mul_f32 v[104:105], v[104:105], v[30:31] op_sel_hi:[1,0]
  v_pk_mul_f32 v[106:107], v[106:107], v[30:31] op_sel_hi:[1,0]
  v_pk_mul_f32 v[108:109], v[108:109], v[30:31] op_sel_hi:[1,0]
  v_pk_mul_f32 v[110:111], v[110:111], v[30:31] op_sel_hi:[1,0]
  v_cvt_pk_bf16_f32 v68, v96, v97
  v_cvt_pk_bf16_f32 v69, v98, v99
  v_cvt_pk_bf16_f32 v70, v100, v101
  v_cvt_pk_bf16_f32 v71, v102, v103
  v_cvt_pk_bf16_f32 v72, v104, v105
  v_cvt_pk_bf16_f32 v73, v106, v107
  v_cvt_pk_bf16_f32 v74, v108, v109
  v_cvt_pk_bf16_f32 v75, v110, v111
  buffer_store_dwordx4 v[68:71], v1, s[28:31], s80 offen offset:1024 sc1
  ds_write_b128 v45, v[68:71] offset:24576
  buffer_store_dwordx4 v[72:75], v1, s[28:31], s80 offen offset:3072 sc1
  ds_write_b128 v45, v[72:75] offset:36864
  s_lshl_b32 s80, s4, 4
  s_add_u32 s80, s80, s5
  s_lshl_b32 s80, s80, 2
  s_add_u32 s80, s80, s6
  s_lshl_b32 s80, s80, 8
  s_add_u32 s80, s80, 65536
  ds_read_b64_tr_b16 v[68:69], v14 offset:5120
  ds_read_b64_tr_b16 v[70:71], v15 offset:5120
  ds_read_b64_tr_b16 v[72:73], v14 offset:6144
  ds_read_b64_tr_b16 v[74:75], v15 offset:6144
  s_waitcnt lgkmcnt(15)
  v_mfma_f32_32x32x16_bf16 v[112:127], v[48:51], v[128:131], 0
  ds_read_b64_tr_b16 v[76:77], v14 offset:7168
  ds_read_b64_tr_b16 v[78:79], v15 offset:7168
  s_waitcnt lgkmcnt(15)
  v_mfma_f32_32x32x16_bf16 v[112:127], v[52:55], v[132:135], v[112:127]
  ds_read_b64_tr_b16 v[48:49], v14 offset:8192
  ds_read_b64_tr_b16 v[50:51], v15 offset:8192
  s_waitcnt lgkmcnt(15)
  v_mfma_f32_32x32x16_bf16 v[112:127], v[56:59], v[136:139], v[112:127]
  ds_read_b64_tr_b16 v[52:53], v14 offset:9216
  ds_read_b64_tr_b16 v[54:55], v15 offset:9216
  s_waitcnt lgkmcnt(15)
  v_mfma_f32_32x32x16_bf16 v[112:127], v[60:63], v[140:143], v[112:127]
  ds_read_b64_tr_b16 v[56:57], v14 offset:10240
  ds_read_b64_tr_b16 v[58:59], v15 offset:10240
  s_waitcnt lgkmcnt(15)
  v_mfma_f32_32x32x16_bf16 v[112:127], v[64:67], v[144:147], v[112:127]
  ds_read_b64_tr_b16 v[60:61], v14 offset:11264
  ds_read_b64_tr_b16 v[62:63], v15 offset:11264
  s_waitcnt lgkmcnt(12)
  v_mfma_f32_32x32x16_bf16 v[112:127], v[68:71], v[148:151], v[112:127]
  ds_read_b64_tr_b16 v[64:65], v14 offset:12288
  ds_read_b64_tr_b16 v[66:67], v15 offset:12288
  s_waitcnt lgkmcnt(12)
  v_mfma_f32_32x32x16_bf16 v[112:127], v[72:75], v[152:155], v[112:127]
  ds_read_b64_tr_b16 v[68:69], v14 offset:13312
  ds_read_b64_tr_b16 v[70:71], v15 offset:13312
  s_waitcnt lgkmcnt(12)
  v_mfma_f32_32x32x16_bf16 v[112:127], v[76:79], v[156:159], v[112:127]
  ds_read_b64_tr_b16 v[72:73], v14 offset:14336
  ds_read_b64_tr_b16 v[74:75], v15 offset:14336
  s_waitcnt lgkmcnt(12)
  v_mfma_f32_32x32x16_bf16 v[112:127], v[48:51], v[160:163], v[112:127]
  ds_read_b64_tr_b16 v[76:77], v14 offset:15360
  ds_read_b64_tr_b16 v[78:79], v15 offset:15360
  s_waitcnt lgkmcnt(12)
  v_mfma_f32_32x32x16_bf16 v[112:127], v[52:55], v[164:167], v[112:127]
  ds_read_b64_tr_b16 v[48:49], v14 offset:16384
  ds_read_b64_tr_b16 v[50:51], v15 offset:16384
  s_waitcnt lgkmcnt(12)
  v_mfma_f32_32x32x16_bf16 v[112:127], v[56:59], v[168:171], v[112:127]
  ds_read_b64_tr_b16 v[52:53], v14 offset:17408
  ds_read_b64_tr_b16 v[54:55], v15 offset:17408
  s_waitcnt lgkmcnt(12)
  v_mfma_f32_32x32x16_bf16 v[112:127], v[60:63], v[172:175], v[112:127]
  ds_read_b64_tr_b16 v[56:57], v14 offset:18432
  ds_read_b64_tr_b16 v[58:59], v15 offset:18432
  s_waitcnt lgkmcnt(12)
  v_mfma_f32_32x32x16_bf16 v[112:127], v[64:67], v[176:179], v[112:127]
  ds_read_b64_tr_b16 v[60:61], v14 offset:19456
  ds_read_b64_tr_b16 v[62:63], v15 offset:19456
  s_waitcnt lgkmcnt(12)
  v_mfma_f32_32x32x16_bf16 v[112:127], v[68:71], v[180:183], v[112:127]
  ds_read_b64_tr_b16 v[64:65], v14 offset:20480
  ds_read_b64_tr_b16 v[66:67], v15 offset:20480
  s_waitcnt lgkmcnt(12)
  v_mfma_f32_32x32x16_bf16 v[112:127], v[72:75], v[184:187], v[112:127]
  ds_read_b64_tr_b16 v[68:69], v14 offset:21504
  ds_read_b64_tr_b16 v[70:71], v15 offset:21504
  s_waitcnt lgkmcnt(12)
  v_mfma_f32_32x32x16_bf16 v[112:127], v[76:79], v[188:191], v[112:127]
  ds_read_b64_tr_b16 v[72:73], v14 offset:22528
  ds_read_b64_tr_b16 v[74:75], v15 offset:22528
  s_waitcnt lgkmcnt(12)
  v_mfma_f32_32x32x16_bf16 v[112:127], v[48:51], v[192:195], v[112:127]
  ds_read_b64_tr_b16 v[76:77], v14 offset:23552
  ds_read_b64_tr_b16 v[78:79], v15 offset:23552
  s_waitcnt lgkmcnt(12)
  v_mfma_f32_32x32x16_bf16 v[112:127], v[52:55], v[196:199], v[112:127]
  ds_read_b64_tr_b16 v[48:49], v14 offset:24576
  ds_read_b64_tr_b16 v[50:51], v15 offset:24576
  s_waitcnt lgkmcnt(12)
  v_mfma_f32_32x32x16_bf16 v[112:127], v[56:59], v[200:203], v[112:127]
  ds_read_b64_tr_b16 v[52:53], v14 offset:25600
  ds_read_b64_tr_b16 v[54:55], v15 offset:25600
  s_waitcnt lgkmcnt(12)
  v_mfma_f32_32x32x16_bf16 v[112:127], v[60:63], v[204:207], v[112:127]
  ds_read_b64_tr_b16 v[56:57], v14 offset:26624
  ds_read_b64_tr_b16 v[58:59], v15 offset:26624
  s_waitcnt lgkmcnt(12)
  v_mfma_f32_32x32x16_bf16 v[112:127], v[64:67], v[208:211], v[112:127]
  ds_read_b64_tr_b16 v[60:61], v14 offset:27648
  ds_read_b64_tr_b16 v[62:63], v15 offset:27648
  s_waitcnt lgkmcnt(12)
  v_mfma_f32_32x32x16_bf16 v[112:127], v[68:71], v[212:215], v[112:127]
  ds_read_b64_tr_b16 v[64:65], v14 offset:28672
  ds_read_b64_tr_b16 v[66:67], v15 offset:28672
  s_waitcnt lgkmcnt(12)
  v_mfma_f32_32x32x16_bf16 v[112:127], v[72:75], v[216:219], v[112:127]
  ds_read_b64_tr_b16 v[68:69], v14 offset:29696
  ds_read_b64_tr_b16 v[70:71], v15 offset:29696
  s_waitcnt lgkmcnt(12)
  v_mfma_f32_32x32x16_bf16 v[112:127], v[76:79], v[220:223], v[112:127]
  ds_read_b64_tr_b16 v[72:73], v14 offset:30720
  ds_read_b64_tr_b16 v[74:75], v15 offset:30720
  s_waitcnt lgkmcnt(12)
  v_mfma_f32_32x32x16_bf16 v[112:127], v[48:51], v[224:227], v[112:127]
  ds_read_b64_tr_b16 v[76:77], v14 offset:31744
  ds_read_b64_tr_b16 v[78:79], v15 offset:31744
  s_waitcnt lgkmcnt(12)
  v_mfma_f32_32x32x16_bf16 v[112:127], v[52:55], v[228:231], v[112:127]
  s_waitcnt lgkmcnt(10)
  v_mfma_f32_32x32x16_bf16 v[112:127], v[56:59], v[232:235], v[112:127]
  s_waitcnt lgkmcnt(8)
  v_mfma_f32_32x32x16_bf16 v[112:127], v[60:63], v[236:239], v[112:127]
  s_waitcnt vmcnt(0)
  v_mov_b32 v22, s46
  s_mov_b64 exec, 1
  buffer_store_dword v22, off, s[28:31], s80 sc1
  s_mov_b64 exec, -1
  s_waitcnt lgkmcnt(6)
  v_mfma_f32_32x32x16_bf16 v[112:127], v[64:67], v[240:243], v[112:127]
  s_waitcnt lgkmcnt(4)
  v_mfma_f32_32x32x16_bf16 v[112:127], v[68:71], v[244:247], v[112:127]
  s_waitcnt lgkmcnt(2)
  v_mfma_f32_32x32x16_bf16 v[112:127], v[72:75], v[248:251], v[112:127]
  s_waitcnt lgkmcnt(0)
  v_mfma_f32_32x32x16_bf16 v[112:127], v[76:79], v[252:255], v[112:127]
  s_barrier
  s_cmp_eq_u32 s3, 0
  s_cbranch_scc0 RES_27
  s_lshr_b32 s80, s5, 3
  s_lshl_b32 s80, s80, 6
  s_and_b32 s81, s6, 1
  s_lshl_b32 s81, s81, 5
  s_add_u32 s80, s80, s81
  s_lshl_b32 s81, s4, 7
  s_add_u32 s80, s80, s81
  s_lshl_b32 s80, s80, 10
  s_and_b32 s81, s5, 7
  s_lshl_b32 s81, s81, 7
  s_add_u32 s80, s80, s81
  s_lshr_b32 s81, s6, 1
  s_lshl_b32 s81, s81, 6
  s_add_u32 s80, s80, s81
  v_and_b32 v46, 31, v0
  v_lshlrev_b32 v46, 10, v46
  v_lshrrev_b32 v47, 5, v0
  v_lshlrev_b32 v47, 3, v47
  v_add_u32 v46, v46, v47
  buffer_load_dwordx2 v[2:3], v46, s[8:11], s80 offen offset:0
  buffer_load_dwordx2 v[4:5], v46, s[8:11], s80 offen offset:16
  buffer_load_dwordx2 v[6:7], v46, s[8:11], s80 offen offset:32
  buffer_load_dwordx2 v[8:9], v46, s[8:11], s80 offen offset:48
RES_27:
  ds_read_b32 v32, v44 offset:256
  v_mul_f32 v30, 0x3eb8aa3b, v30
  s_lshl_b32 s80, s6, 10
  s_add_u32 s80, s80, 147456
  v_add_u32 v45, s80, v1
  s_waitcnt lgkmcnt(0)
  v_mfma_f32_32x32x16_bf16 v[112:127], v[32:35], v[40:43], v[112:127]
  s_nop 11
  v_pk_mul_f32 v[112:113], v[112:113], v[30:31] op_sel_hi:[1,0]
  v_pk_mul_f32 v[114:115], v[114:115], v[30:31] op_sel_hi:[1,0]
  v_pk_mul_f32 v[116:117], v[116:117], v[30:31] op_sel_hi:[1,0]
  v_pk_mul_f32 v[118:119], v[118:119], v[30:31] op_sel_hi:[1,0]
  v_pk_mul_f32 v[120:121], v[120:121], v[30:31] op_sel_hi:[1,0]
  v_pk_mul_f32 v[122:123], v[122:123], v[30:31] op_sel_hi:[1,0]
  v_pk_mul_f32 v[124:125], v[124:125], v[30:31] op_sel_hi:[1,0]
  v_pk_mul_f32 v[126:127], v[126:127], v[30:31] op_sel_hi:[1,0]
  v_cvt_pk_bf16_f32 v68, v112, v113
  v_cvt_pk_bf16_f32 v69, v114, v115
  v_cvt_pk_bf16_f32 v70, v116, v117
  v_cvt_pk_bf16_f32 v71, v118, v119
  v_cvt_pk_bf16_f32 v72, v120, v121
  v_cvt_pk_bf16_f32 v73, v122, v123
  v_cvt_pk_bf16_f32 v74, v124, v125
  v_cvt_pk_bf16_f32 v75, v126, v127
  ds_write_b128 v45, v[68:71] offset:0
  ds_write_b128 v45, v[72:75] offset:4096
  s_waitcnt lgkmcnt(0)
  s_barrier
  v_mov_b32 v16, 161792
  ds_read_b32 v17, v16
  s_lshl_b32 s83, s6, 10
  s_add_u32 s82, s83, 98304
  v_add_u32 v12, s82, v1
  s_add_u32 s82, s83, 147456
  v_add_u32 v23, s82, v1
  s_lshl_b32 s82, s4, 2
  s_add_u32 s82, s82, s6
  s_sub_i32 s84, 8, s82
  s_max_i32 s84, s84, 0
  s_lshl_b32 s89, s82, 15
  s_lshl_b32 s82, s5, 11
  s_add_u32 s89, s89, s82
  s_lshl_b32 s82, s3, 21
  s_add_u32 s89, s89, s82
  s_add_u32 s89, s89, 10485760
  v_and_b32 v18, 1, v0
  v_lshlrev_b32 v18, 9, v18
  v_lshrrev_b32 v19, 5, v0
  v_lshlrev_b32 v19, 2, v19
  v_and_b32 v20, 15, v0
  v_lshrrev_b32 v20, 2, v20
  v_add_u32 v19, v19, v20
  v_lshlrev_b32 v19, 4, v19
  v_add_u32 v18, v18, v19
  v_lshrrev_b32 v19, 1, v0
  v_and_b32 v19, 1, v19
  v_lshlrev_b32 v19, 3, v19
  v_add_u32 v18, v18, v19
  s_add_u32 s83, s83, 122880
  v_add_u32 v18, s83, v18
  v_add_u32 v19, 159744, v19
  v_and_b32 v20, 16, v0
  v_cmp_eq_u32 vcc, 0, v20
  v_mov_b32 v21, 1024
  s_nop 0
  v_cndmask_b32 v22, v19, v18, vcc
  v_cndmask_b32 v14, 0, v21, vcc
  s_mov_b32 s88, 0
  s_waitcnt lgkmcnt(0)
  v_readfirstlane_b32 s7, v17
L_UNIT:
  ds_read_b128 v[244:247], v23
  ds_read_b128 v[208:211], v12 offset:0
  ds_read_b128 v[212:215], v12 offset:8192
  ds_read_b128 v[216:219], v12 offset:1024
  ds_read_b128 v[220:223], v12 offset:2048
  ds_read_b128 v[224:227], v12 offset:3072
  ds_read_b128 v[228:231], v12 offset:4096
  ds_read_b128 v[232:235], v12 offset:5120
  ds_read_b128 v[236:239], v12 offset:6144
  ds_read_b128 v[240:243], v12 offset:7168
  v_add_u32 v13, v22, v14
  s_cmp_lg_u32 s84, 0
  s_cbranch_scc1 SGEN_28
  s_waitcnt lgkmcnt(8)
  v_mfma_f32_32x32x16_bf16 v[64:79], v[208:211], v[244:247], 0
  s_waitcnt lgkmcnt(7)
  v_mfma_f32_32x32x16_bf16 v[192:207], v[212:215], v[244:247], 0
  s_waitcnt lgkmcnt(6)
  v_mfma_f32_32x32x16_bf16 v[80:95], v[216:219], v[244:247], 0
  s_waitcnt lgkmcnt(5)
  v_mfma_f32_32x32x16_bf16 v[96:111], v[220:223], v[244:247], 0
  s_nop 7
  v_cndmask_b32 v192, v64, v192, s[48:49]
  v_cndmask_b32 v193, v65, v193, s[50:51]
  v_cndmask_b32 v194, v66, v194, s[52:53]
  v_cndmask_b32 v195, v67, v195, s[54:55]
  v_cndmask_b32 v196, v68, v196, s[56:57]
  v_cndmask_b32 v197, v69, v197, s[58:59]
  v_cndmask_b32 v198, v70, v198, s[60:61]
  v_cndmask_b32 v199, v71, v199, s[62:63]
  v_cndmask_b32 v200, v72, v200, s[64:65]
  v_cndmask_b32 v201, v73, v201, s[66:67]
  v_cndmask_b32 v202, v74, v202, s[68:69]
  v_cndmask_b32 v203, v75, v203, s[70:71]
  v_cndmask_b32 v204, v76, v204, s[72:73]
  v_cndmask_b32 v205, v77, v205, s[74:75]
  v_cndmask_b32 v206, v78, v206, s[76:77]
  v_cndmask_b32 v207, v79, v207, s[78:79]
  s_waitcnt lgkmcnt(4)
  v_mfma_f32_32x32x16_bf16 v[112:127], v[224:227], v[244:247], 0
  v_max3_f32 v15, v192, v193, v194
  v_max_f32 v15, v15, v195
  v_max3_f32 v15, v15, v196, v197
  v_max3_f32 v15, v15, v198, v199
  v_max3_f32 v15, v15, v200, v201
  v_max3_f32 v15, v15, v202, v203
  v_max3_f32 v15, v15, v204, v205
  v_max3_f32 v15, v15, v206, v207
  s_waitcnt lgkmcnt(3)
  v_mfma_f32_32x32x16_bf16 v[128:143], v[228:231], v[244:247], 0
  v_max3_f32 v16, v80, v81, v82
  v_max_f32 v16, v16, v83
  v_max3_f32 v16, v16, v84, v85
  v_max3_f32 v16, v16, v86, v87
  v_max3_f32 v16, v16, v88, v89
  v_max3_f32 v16, v16, v90, v91
  v_max3_f32 v16, v16, v92, v93
  v_max3_f32 v16, v16, v94, v95
  s_waitcnt lgkmcnt(2)
  v_mfma_f32_32x32x16_bf16 v[144:159], v[232:235], v[244:247], 0
  v_max3_f32 v17, v96, v97, v98
  v_max_f32 v17, v17, v99
  v_max3_f32 v17, v17, v100, v101
  v_max3_f32 v17, v17, v102, v103
  v_max3_f32 v17, v17, v104, v105
  v_max3_f32 v17, v17, v106, v107
  v_max3_f32 v17, v17, v108, v109
  v_max3_f32 v17, v17, v110, v111
  s_waitcnt lgkmcnt(1)
  v_mfma_f32_32x32x16_bf16 v[160:175], v[236:239], v[244:247], 0
  v_max3_f32 v18, v112, v113, v114
  v_max_f32 v18, v18, v115
  v_max3_f32 v18, v18, v116, v117
  v_max3_f32 v18, v18, v118, v119
  v_max3_f32 v18, v18, v120, v121
  v_max3_f32 v18, v18, v122, v123
  v_max3_f32 v18, v18, v124, v125
  v_max3_f32 v18, v18, v126, v127
  s_waitcnt lgkmcnt(0)
  v_mfma_f32_32x32x16_bf16 v[176:191], v[240:243], v[244:247], 0
  v_max3_f32 v15, v15, v128, v129
  v_max3_f32 v15, v15, v130, v131
  v_max3_f32 v15, v15, v132, v133
  v_max3_f32 v15, v15, v134, v135
  v_max3_f32 v15, v15, v136, v137
  v_max3_f32 v15, v15, v138, v139
  v_max3_f32 v15, v15, v140, v141
  v_max3_f32 v15, v15, v142, v143
  v_max3_f32 v16, v16, v144, v145
  v_max3_f32 v16, v16, v146, v147
  v_max3_f32 v16, v16, v148, v149
  v_max3_f32 v16, v16, v150, v151
  v_max3_f32 v16, v16, v152, v153
  v_max3_f32 v16, v16, v154, v155
  v_max3_f32 v16, v16, v156, v157
  v_max3_f32 v16, v16, v158, v159
  v_max3_f32 v17, v17, v160, v161
  v_max3_f32 v17, v17, v162, v163
  v_max3_f32 v17, v17, v164, v165
  v_max3_f32 v17, v17, v166, v167
  v_max3_f32 v17, v17, v168, v169
  v_max3_f32 v17, v17, v170, v171
  v_max3_f32 v17, v17, v172, v173
  v_max3_f32 v17, v17, v174, v175
  v_max3_f32 v18, v18, v176, v177
  v_max3_f32 v18, v18, v178, v179
  v_max3_f32 v18, v18, v180, v181
  v_max3_f32 v18, v18, v182, v183
  v_max3_f32 v18, v18, v184, v185
  v_max3_f32 v18, v18, v186, v187
  v_max3_f32 v18, v18, v188, v189
  v_max3_f32 v18, v18, v190, v191
  s_branch SJOIN_29
SGEN_28:
  s_waitcnt lgkmcnt(0)
  v_mfma_f32_32x32x16_bf16 v[64:79], v[208:211], v[244:247], 0
  v_mfma_f32_32x32x16_bf16 v[192:207], v[212:215], v[244:247], 0
  v_mfma_f32_32x32x16_bf16 v[80:95], v[216:219], v[244:247], 0
  v_mfma_f32_32x32x16_bf16 v[96:111], v[220:223], v[244:247], 0
  v_mfma_f32_32x32x16_bf16 v[112:127], v[224:227], v[244:247], 0
  v_mfma_f32_32x32x16_bf16 v[128:143], v[228:231], v[244:247], 0
  v_mfma_f32_32x32x16_bf16 v[144:159], v[232:235], v[244:247], 0
  v_mfma_f32_32x32x16_bf16 v[160:175], v[236:239], v[244:247], 0
  v_mfma_f32_32x32x16_bf16 v[176:191], v[240:243], v[244:247], 0
  s_nop 7
  s_nop 7
  s_cmp_gt_i32 s84, 0
  s_cbranch_scc0 SINV_30
  v_mov_b32 v64, 0xff800000
  v_mov_b32 v65, 0xff800000
  v_mov_b32 v66, 0xff800000
  v_mov_b32 v67, 0xff800000
  v_mov_b32 v68, 0xff800000
  v_mov_b32 v69, 0xff800000
  v_mov_b32 v70, 0xff800000
  v_mov_b32 v71, 0xff800000
  v_mov_b32 v72, 0xff800000
  v_mov_b32 v73, 0xff800000
  v_mov_b32 v74, 0xff800000
  v_mov_b32 v75, 0xff800000
  v_mov_b32 v76, 0xff800000
  v_mov_b32 v77, 0xff800000
  v_mov_b32 v78, 0xff800000
  v_mov_b32 v79, 0xff800000
SINV_30:
  s_cmp_gt_i32 s84, 1
  s_cbranch_scc0 SINV_31
  v_mov_b32 v80, 0xff800000
  v_mov_b32 v81, 0xff800000
  v_mov_b32 v82, 0xff800000
  v_mov_b32 v83, 0xff800000
  v_mov_b32 v84, 0xff800000
  v_mov_b32 v85, 0xff800000
  v_mov_b32 v86, 0xff800000
  v_mov_b32 v87, 0xff800000
  v_mov_b32 v88, 0xff800000
  v_mov_b32 v89, 0xff800000
  v_mov_b32 v90, 0xff800000
  v_mov_b32 v91, 0xff800000
  v_mov_b32 v92, 0xff800000
  v_mov_b32 v93, 0xff800000
  v_mov_b32 v94, 0xff800000
  v_mov_b32 v95, 0xff800000
SINV_31:
  s_cmp_gt_i32 s84, 2
  s_cbranch_scc0 SINV_32
  v_mov_b32 v96, 0xff800000
  v_mov_b32 v97, 0xff800000
  v_mov_b32 v98, 0xff800000
  v_mov_b32 v99, 0xff800000
  v_mov_b32 v100, 0xff800000
  v_mov_b32 v101, 0xff800000
  v_mov_b32 v102, 0xff800000
  v_mov_b32 v103, 0xff800000
  v_mov_b32 v104, 0xff800000
  v_mov_b32 v105, 0xff800000
  v_mov_b32 v106, 0xff800000
  v_mov_b32 v107, 0xff800000
  v_mov_b32 v108, 0xff800000
  v_mov_b32 v109, 0xff800000
  v_mov_b32 v110, 0xff800000
  v_mov_b32 v111, 0xff800000
SINV_32:
  s_cmp_gt_i32 s84, 3
  s_cbranch_scc0 SINV_33
  v_mov_b32 v112, 0xff800000
  v_mov_b32 v113, 0xff800000
  v_mov_b32 v114, 0xff800000
  v_mov_b32 v115, 0xff800000
  v_mov_b32 v116, 0xff800000
  v_mov_b32 v117, 0xff800000
  v_mov_b32 v118, 0xff800000
  v_mov_b32 v119, 0xff800000
  v_mov_b32 v120, 0xff800000
  v_mov_b32 v121, 0xff800000
  v_mov_b32 v122, 0xff800000
  v_mov_b32 v123, 0xff800000
  v_mov_b32 v124, 0xff800000
  v_mov_b32 v125, 0xff800000
  v_mov_b32 v126, 0xff800000
  v_mov_b32 v127, 0xff800000
SINV_33:
  s_cmp_gt_i32 s84, 4
  s_cbranch_scc0 SINV_34
  v_mov_b32 v128, 0xff800000
  v_mov_b32 v129, 0xff800000
  v_mov_b32 v130, 0xff800000
  v_mov_b32 v131, 0xff800000
  v_mov_b32 v132, 0xff800000
  v_mov_b32 v133, 0xff800000
  v_mov_b32 v134, 0xff800000
  v_mov_b32 v135, 0xff800000
  v_mov_b32 v136, 0xff800000
  v_mov_b32 v137, 0xff800000
  v_mov_b32 v138, 0xff800000
  v_mov_b32 v139, 0xff800000
  v_mov_b32 v140, 0xff800000
  v_mov_b32 v141, 0xff800000
  v_mov_b32 v142, 0xff800000
  v_mov_b32 v143, 0xff800000
SINV_34:
  s_cmp_gt_i32 s84, 5
  s_cbranch_scc0 SINV_35
  v_mov_b32 v144, 0xff800000
  v_mov_b32 v145, 0xff800000
  v_mov_b32 v146, 0xff800000
  v_mov_b32 v147, 0xff800000
  v_mov_b32 v148, 0xff800000
  v_mov_b32 v149, 0xff800000
  v_mov_b32 v150, 0xff800000
  v_mov_b32 v151, 0xff800000
  v_mov_b32 v152, 0xff800000
  v_mov_b32 v153, 0xff800000
  v_mov_b32 v154, 0xff800000
  v_mov_b32 v155, 0xff800000
  v_mov_b32 v156, 0xff800000
  v_mov_b32 v157, 0xff800000
  v_mov_b32 v158, 0xff800000
  v_mov_b32 v159, 0xff800000
SINV_35:
  s_cmp_gt_i32 s84, 6
  s_cbranch_scc0 SINV_36
  v_mov_b32 v160, 0xff800000
  v_mov_b32 v161, 0xff800000
  v_mov_b32 v162, 0xff800000
  v_mov_b32 v163, 0xff800000
  v_mov_b32 v164, 0xff800000
  v_mov_b32 v165, 0xff800000
  v_mov_b32 v166, 0xff800000
  v_mov_b32 v167, 0xff800000
  v_mov_b32 v168, 0xff800000
  v_mov_b32 v169, 0xff800000
  v_mov_b32 v170, 0xff800000
  v_mov_b32 v171, 0xff800000
  v_mov_b32 v172, 0xff800000
  v_mov_b32 v173, 0xff800000
  v_mov_b32 v174, 0xff800000
  v_mov_b32 v175, 0xff800000
SINV_36:
  s_cmp_gt_i32 s84, 7
  s_cbranch_scc0 SINV_37
  v_mov_b32 v176, 0xff800000
  v_mov_b32 v177, 0xff800000
  v_mov_b32 v178, 0xff800000
  v_mov_b32 v179, 0xff800000
  v_mov_b32 v180, 0xff800000
  v_mov_b32 v181, 0xff800000
  v_mov_b32 v182, 0xff800000
  v_mov_b32 v183, 0xff800000
  v_mov_b32 v184, 0xff800000
  v_mov_b32 v185, 0xff800000
  v_mov_b32 v186, 0xff800000
  v_mov_b32 v187, 0xff800000
  v_mov_b32 v188, 0xff800000
  v_mov_b32 v189, 0xff800000
  v_mov_b32 v190, 0xff800000
  v_mov_b32 v191, 0xff800000
SINV_37:
  v_cndmask_b32 v192, v64, v192, s[48:49]
  v_cndmask_b32 v193, v65, v193, s[50:51]
  v_cndmask_b32 v194, v66, v194, s[52:53]
  v_cndmask_b32 v195, v67, v195, s[54:55]
  v_cndmask_b32 v196, v68, v196, s[56:57]
  v_cndmask_b32 v197, v69, v197, s[58:59]
  v_cndmask_b32 v198, v70, v198, s[60:61]
  v_cndmask_b32 v199, v71, v199, s[62:63]
  v_cndmask_b32 v200, v72, v200, s[64:65]
  v_cndmask_b32 v201, v73, v201, s[66:67]
  v_cndmask_b32 v202, v74, v202, s[68:69]
  v_cndmask_b32 v203, v75, v203, s[70:71]
  v_cndmask_b32 v204, v76, v204, s[72:73]
  v_cndmask_b32 v205, v77, v205, s[74:75]
  v_cndmask_b32 v206, v78, v206, s[76:77]
  v_cndmask_b32 v207, v79, v207, s[78:79]
  v_max3_f32 v15, v192, v193, v194
  v_max_f32 v15, v15, v195
  v_max3_f32 v15, v15, v196, v197
  v_max3_f32 v15, v15, v198, v199
  v_max3_f32 v15, v15, v200, v201
  v_max3_f32 v15, v15, v202, v203
  v_max3_f32 v15, v15, v204, v205
  v_max3_f32 v15, v15, v206, v207
  v_max3_f32 v16, v80, v81, v82
  v_max_f32 v16, v16, v83
  v_max3_f32 v16, v16, v84, v85
  v_max3_f32 v16, v16, v86, v87
  v_max3_f32 v16, v16, v88, v89
  v_max3_f32 v16, v16, v90, v91
  v_max3_f32 v16, v16, v92, v93
  v_max3_f32 v16, v16, v94, v95
  v_max3_f32 v17, v96, v97, v98
  v_max_f32 v17, v17, v99
  v_max3_f32 v17, v17, v100, v101
  v_max3_f32 v17, v17, v102, v103
  v_max3_f32 v17, v17, v104, v105
  v_max3_f32 v17, v17, v106, v107
  v_max3_f32 v17, v17, v108, v109
  v_max3_f32 v17, v17, v110, v111
  v_max3_f32 v18, v112, v113, v114
  v_max_f32 v18, v18, v115
  v_max3_f32 v18, v18, v116, v117
  v_max3_f32 v18, v18, v118, v119
  v_max3_f32 v18, v18, v120, v121
  v_max3_f32 v18, v18, v122, v123
  v_max3_f32 v18, v18, v124, v125
  v_max3_f32 v18, v18, v126, v127
  v_max3_f32 v15, v15, v128, v129
  v_max3_f32 v15, v15, v130, v131
  v_max3_f32 v15, v15, v132, v133
  v_max3_f32 v15, v15, v134, v135
  v_max3_f32 v15, v15, v136, v137
  v_max3_f32 v15, v15, v138, v139
  v_max3_f32 v15, v15, v140, v141
  v_max3_f32 v15, v15, v142, v143
  v_max3_f32 v16, v16, v144, v145
  v_max3_f32 v16, v16, v146, v147
  v_max3_f32 v16, v16, v148, v149
  v_max3_f32 v16, v16, v150, v151
  v_max3_f32 v16, v16, v152, v153
  v_max3_f32 v16, v16, v154, v155
  v_max3_f32 v16, v16, v156, v157
  v_max3_f32 v16, v16, v158, v159
  v_max3_f32 v17, v17, v160, v161
  v_max3_f32 v17, v17, v162, v163
  v_max3_f32 v17, v17, v164, v165
  v_max3_f32 v17, v17, v166, v167
  v_max3_f32 v17, v17, v168, v169
  v_max3_f32 v17, v17, v170, v171
  v_max3_f32 v17, v17, v172, v173
  v_max3_f32 v17, v17, v174, v175
  v_max3_f32 v18, v18, v176, v177
  v_max3_f32 v18, v18, v178, v179
  v_max3_f32 v18, v18, v180, v181
  v_max3_f32 v18, v18, v182, v183
  v_max3_f32 v18, v18, v184, v185
  v_max3_f32 v18, v18, v186, v187
  v_max3_f32 v18, v18, v188, v189
  v_max3_f32 v18, v18, v190, v191
SJOIN_29:
  ds_read_b64_tr_b16 v[208:209], v13 offset:0
  ds_read_b64_tr_b16 v[210:211], v13 offset:128
  ds_read_b64_tr_b16 v[212:213], v13 offset:256
  ds_read_b64_tr_b16 v[214:215], v13 offset:384
  v_add_u32 v13, v13, v14
  ds_read_b64_tr_b16 v[216:217], v13 offset:0
  ds_read_b64_tr_b16 v[218:219], v13 offset:128
  ds_read_b64_tr_b16 v[220:221], v13 offset:256
  ds_read_b64_tr_b16 v[222:223], v13 offset:384
  v_max3_f32 v15, v15, v16, v17
  v_max_f32 v15, v15, v18
  v_mov_b32 v16, v15
  s_nop 1
  v_permlane32_swap_b32 v15, v16
  v_max_f32 v15, v15, v16
  v_sub_f32 v20, 0, v15
  v_pk_add_f32 v[80:81], v[80:81], v[20:21] op_sel_hi:[1,0]
  v_pk_add_f32 v[82:83], v[82:83], v[20:21] op_sel_hi:[1,0]
  v_pk_add_f32 v[84:85], v[84:85], v[20:21] op_sel_hi:[1,0]
  v_pk_add_f32 v[86:87], v[86:87], v[20:21] op_sel_hi:[1,0]
  v_pk_add_f32 v[88:89], v[88:89], v[20:21] op_sel_hi:[1,0]
  v_pk_add_f32 v[90:91], v[90:91], v[20:21] op_sel_hi:[1,0]
  v_pk_add_f32 v[92:93], v[92:93], v[20:21] op_sel_hi:[1,0]
  v_pk_add_f32 v[94:95], v[94:95], v[20:21] op_sel_hi:[1,0]
  v_exp_f32 v80, v80
  v_exp_f32 v81, v81
  v_exp_f32 v82, v82
  v_exp_f32 v83, v83
  v_exp_f32 v84, v84
  v_exp_f32 v85, v85
  v_exp_f32 v86, v86
  v_exp_f32 v87, v87
  v_exp_f32 v88, v88
  v_exp_f32 v89, v89
  v_exp_f32 v90, v90
  v_exp_f32 v91, v91
  v_exp_f32 v92, v92
  v_exp_f32 v93, v93
  v_exp_f32 v94, v94
  v_exp_f32 v95, v95
  v_cvt_pk_bf16_f32 v48, v80, v81
  v_cvt_pk_bf16_f32 v49, v82, v83
  v_cvt_pk_bf16_f32 v50, v84, v85
  v_cvt_pk_bf16_f32 v51, v86, v87
  v_cvt_pk_bf16_f32 v52, v88, v89
  v_cvt_pk_bf16_f32 v53, v90, v91
  v_cvt_pk_bf16_f32 v54, v92, v93
  v_cvt_pk_bf16_f32 v55, v94, v95
  s_waitcnt lgkmcnt(4)
  v_mfma_f32_32x32x16_bf16 v[32:47], v[208:211], v[48:51], 0
  v_mfma_f32_32x32x16_bf16 v[32:47], v[212:215], v[52:55], v[32:47]
  v_add_u32 v13, v13, v14
  ds_read_b64_tr_b16 v[224:225], v13 offset:0
  ds_read_b64_tr_b16 v[226:227], v13 offset:128
  ds_read_b64_tr_b16 v[228:229], v13 offset:256
  ds_read_b64_tr_b16 v[230:231], v13 offset:384
  v_pk_add_f32 v[96:97], v[96:97], v[20:21] op_sel_hi:[1,0]
  v_pk_add_f32 v[98:99], v[98:99], v[20:21] op_sel_hi:[1,0]
  v_pk_add_f32 v[100:101], v[100:101], v[20:21] op_sel_hi:[1,0]
  v_pk_add_f32 v[102:103], v[102:103], v[20:21] op_sel_hi:[1,0]
  v_pk_add_f32 v[104:105], v[104:105], v[20:21] op_sel_hi:[1,0]
  v_pk_add_f32 v[106:107], v[106:107], v[20:21] op_sel_hi:[1,0]
  v_pk_add_f32 v[108:109], v[108:109], v[20:21] op_sel_hi:[1,0]
  v_pk_add_f32 v[110:111], v[110:111], v[20:21] op_sel_hi:[1,0]
  v_exp_f32 v96, v96
  v_exp_f32 v97, v97
  v_exp_f32 v98, v98
  v_exp_f32 v99, v99
  v_exp_f32 v100, v100
  v_exp_f32 v101, v101
  v_exp_f32 v102, v102
  v_exp_f32 v103, v103
  v_exp_f32 v104, v104
  v_exp_f32 v105, v105
  v_exp_f32 v106, v106
  v_exp_f32 v107, v107
  v_exp_f32 v108, v108
  v_exp_f32 v109, v109
  v_exp_f32 v110, v110
  v_exp_f32 v111, v111
  v_cvt_pk_bf16_f32 v56, v96, v97
  v_cvt_pk_bf16_f32 v57, v98, v99
  v_cvt_pk_bf16_f32 v58, v100, v101
  v_cvt_pk_bf16_f32 v59, v102, v103
  v_cvt_pk_bf16_f32 v60, v104, v105
  v_cvt_pk_bf16_f32 v61, v106, v107
  v_cvt_pk_bf16_f32 v62, v108, v109
  v_cvt_pk_bf16_f32 v63, v110, v111
  s_waitcnt lgkmcnt(4)
  v_mfma_f32_32x32x16_bf16 v[32:47], v[216:219], v[56:59], v[32:47]
  v_mfma_f32_32x32x16_bf16 v[32:47], v[220:223], v[60:63], v[32:47]
  v_add_u32 v13, v13, v14
  ds_read_b64_tr_b16 v[208:209], v13 offset:0
  ds_read_b64_tr_b16 v[210:211], v13 offset:128
  ds_read_b64_tr_b16 v[212:213], v13 offset:256
  ds_read_b64_tr_b16 v[214:215], v13 offset:384
  v_pk_add_f32 v[112:113], v[112:113], v[20:21] op_sel_hi:[1,0]
  v_pk_add_f32 v[114:115], v[114:115], v[20:21] op_sel_hi:[1,0]
  v_pk_add_f32 v[116:117], v[116:117], v[20:21] op_sel_hi:[1,0]
  v_pk_add_f32 v[118:119], v[118:119], v[20:21] op_sel_hi:[1,0]
  v_pk_add_f32 v[120:121], v[120:121], v[20:21] op_sel_hi:[1,0]
  v_pk_add_f32 v[122:123], v[122:123], v[20:21] op_sel_hi:[1,0]
  v_pk_add_f32 v[124:125], v[124:125], v[20:21] op_sel_hi:[1,0]
  v_pk_add_f32 v[126:127], v[126:127], v[20:21] op_sel_hi:[1,0]
  v_exp_f32 v112, v112
  v_exp_f32 v113, v113
  v_exp_f32 v114, v114
  v_exp_f32 v115, v115
  v_exp_f32 v116, v116
  v_exp_f32 v117, v117
  v_exp_f32 v118, v118
  v_exp_f32 v119, v119
  v_exp_f32 v120, v120
  v_exp_f32 v121, v121
  v_exp_f32 v122, v122
  v_exp_f32 v123, v123
  v_exp_f32 v124, v124
  v_exp_f32 v125, v125
  v_exp_f32 v126, v126
  v_exp_f32 v127, v127
  v_cvt_pk_bf16_f32 v48, v112, v113
  v_cvt_pk_bf16_f32 v49, v114, v115
  v_cvt_pk_bf16_f32 v50, v116, v117
  v_cvt_pk_bf16_f32 v51, v118, v119
  v_cvt_pk_bf16_f32 v52, v120, v121
  v_cvt_pk_bf16_f32 v53, v122, v123
  v_cvt_pk_bf16_f32 v54, v124, v125
  v_cvt_pk_bf16_f32 v55, v126, v127
  s_waitcnt lgkmcnt(4)
  v_mfma_f32_32x32x16_bf16 v[32:47], v[224:227], v[48:51], v[32:47]
  v_mfma_f32_32x32x16_bf16 v[32:47], v[228:231], v[52:55], v[32:47]
  v_add_u32 v13, v13, v14
  ds_read_b64_tr_b16 v[216:217], v13 offset:0
  ds_read_b64_tr_b16 v[218:219], v13 offset:128
  ds_read_b64_tr_b16 v[220:221], v13 offset:256
  ds_read_b64_tr_b16 v[222:223], v13 offset:384
  v_pk_add_f32 v[128:129], v[128:129], v[20:21] op_sel_hi:[1,0]
  v_pk_add_f32 v[130:131], v[130:131], v[20:21] op_sel_hi:[1,0]
  v_pk_add_f32 v[132:133], v[132:133], v[20:21] op_sel_hi:[1,0]
  v_pk_add_f32 v[134:135], v[134:135], v[20:21] op_sel_hi:[1,0]
  v_pk_add_f32 v[136:137], v[136:137], v[20:21] op_sel_hi:[1,0]
  v_pk_add_f32 v[138:139], v[138:139], v[20:21] op_sel_hi:[1,0]
  v_pk_add_f32 v[140:141], v[140:141], v[20:21] op_sel_hi:[1,0]
  v_pk_add_f32 v[142:143], v[142:143], v[20:21] op_sel_hi:[1,0]
  v_exp_f32 v128, v128
  v_exp_f32 v129, v129
  v_exp_f32 v130, v130
  v_exp_f32 v131, v131
  v_exp_f32 v132, v132
  v_exp_f32 v133, v133
  v_exp_f32 v134, v134
  v_exp_f32 v135, v135
  v_exp_f32 v136, v136
  v_exp_f32 v137, v137
  v_exp_f32 v138, v138
  v_exp_f32 v139, v139
  v_exp_f32 v140, v140
  v_exp_f32 v141, v141
  v_exp_f32 v142, v142
  v_exp_f32 v143, v143
  v_cvt_pk_bf16_f32 v56, v128, v129
  v_cvt_pk_bf16_f32 v57, v130, v131
  v_cvt_pk_bf16_f32 v58, v132, v133
  v_cvt_pk_bf16_f32 v59, v134, v135
  v_cvt_pk_bf16_f32 v60, v136, v137
  v_cvt_pk_bf16_f32 v61, v138, v139
  v_cvt_pk_bf16_f32 v62, v140, v141
  v_cvt_pk_bf16_f32 v63, v142, v143
  s_waitcnt lgkmcnt(4)
  v_mfma_f32_32x32x16_bf16 v[32:47], v[208:211], v[56:59], v[32:47]
  v_mfma_f32_32x32x16_bf16 v[32:47], v[212:215], v[60:63], v[32:47]
  v_add_u32 v13, v13, v14
  ds_read_b64_tr_b16 v[224:225], v13 offset:0
  ds_read_b64_tr_b16 v[226:227], v13 offset:128
  ds_read_b64_tr_b16 v[228:229], v13 offset:256
  ds_read_b64_tr_b16 v[230:231], v13 offset:384
  v_pk_add_f32 v[144:145], v[144:145], v[20:21] op_sel_hi:[1,0]
  v_pk_add_f32 v[146:147], v[146:147], v[20:21] op_sel_hi:[1,0]
  v_pk_add_f32 v[148:149], v[148:149], v[20:21] op_sel_hi:[1,0]
  v_pk_add_f32 v[150:151], v[150:151], v[20:21] op_sel_hi:[1,0]
  v_pk_add_f32 v[152:153], v[152:153], v[20:21] op_sel_hi:[1,0]
  v_pk_add_f32 v[154:155], v[154:155], v[20:21] op_sel_hi:[1,0]
  v_pk_add_f32 v[156:157], v[156:157], v[20:21] op_sel_hi:[1,0]
  v_pk_add_f32 v[158:159], v[158:159], v[20:21] op_sel_hi:[1,0]
  v_exp_f32 v144, v144
  v_exp_f32 v145, v145
  v_exp_f32 v146, v146
  v_exp_f32 v147, v147
  v_exp_f32 v148, v148
  v_exp_f32 v149, v149
  v_exp_f32 v150, v150
  v_exp_f32 v151, v151
  v_exp_f32 v152, v152
  v_exp_f32 v153, v153
  v_exp_f32 v154, v154
  v_exp_f32 v155, v155
  v_exp_f32 v156, v156
  v_exp_f32 v157, v157
  v_exp_f32 v158, v158
  v_exp_f32 v159, v159
  v_cvt_pk_bf16_f32 v48, v144, v145
  v_cvt_pk_bf16_f32 v49, v146, v147
  v_cvt_pk_bf16_f32 v50, v148, v149
  v_cvt_pk_bf16_f32 v51, v150, v151
  v_cvt_pk_bf16_f32 v52, v152, v153
  v_cvt_pk_bf16_f32 v53, v154, v155
  v_cvt_pk_bf16_f32 v54, v156, v157
  v_cvt_pk_bf16_f32 v55, v158, v159
  s_waitcnt lgkmcnt(4)
  v_mfma_f32_32x32x16_bf16 v[32:47], v[216:219], v[48:51], v[32:47]
  v_mfma_f32_32x32x16_bf16 v[32:47], v[220:223], v[52:55], v[32:47]
  v_add_u32 v13, v13, v14
  ds_read_b64_tr_b16 v[208:209], v13 offset:0
  ds_read_b64_tr_b16 v[210:211], v13 offset:128
  ds_read_b64_tr_b16 v[212:213], v13 offset:256
  ds_read_b64_tr_b16 v[214:215], v13 offset:384
  v_pk_add_f32 v[160:161], v[160:161], v[20:21] op_sel_hi:[1,0]
  v_pk_add_f32 v[162:163], v[162:163], v[20:21] op_sel_hi:[1,0]
  v_pk_add_f32 v[164:165], v[164:165], v[20:21] op_sel_hi:[1,0]
  v_pk_add_f32 v[166:167], v[166:167], v[20:21] op_sel_hi:[1,0]
  v_pk_add_f32 v[168:169], v[168:169], v[20:21] op_sel_hi:[1,0]
  v_pk_add_f32 v[170:171], v[170:171], v[20:21] op_sel_hi:[1,0]
  v_pk_add_f32 v[172:173], v[172:173], v[20:21] op_sel_hi:[1,0]
  v_pk_add_f32 v[174:175], v[174:175], v[20:21] op_sel_hi:[1,0]
  v_exp_f32 v160, v160
  v_exp_f32 v161, v161
  v_exp_f32 v162, v162
  v_exp_f32 v163, v163
  v_exp_f32 v164, v164
  v_exp_f32 v165, v165
  v_exp_f32 v166, v166
  v_exp_f32 v167, v167
  v_exp_f32 v168, v168
  v_exp_f32 v169, v169
  v_exp_f32 v170, v170
  v_exp_f32 v171, v171
  v_exp_f32 v172, v172
  v_exp_f32 v173, v173
  v_exp_f32 v174, v174
  v_exp_f32 v175, v175
  v_cvt_pk_bf16_f32 v56, v160, v161
  v_cvt_pk_bf16_f32 v57, v162, v163
  v_cvt_pk_bf16_f32 v58, v164, v165
  v_cvt_pk_bf16_f32 v59, v166, v167
  v_cvt_pk_bf16_f32 v60, v168, v169
  v_cvt_pk_bf16_f32 v61, v170, v171
  v_cvt_pk_bf16_f32 v62, v172, v173
  v_cvt_pk_bf16_f32 v63, v174, v175
  s_waitcnt lgkmcnt(4)
  v_mfma_f32_32x32x16_bf16 v[32:47], v[224:227], v[56:59], v[32:47]
  v_mfma_f32_32x32x16_bf16 v[32:47], v[228:231], v[60:63], v[32:47]
  v_add_u32 v13, v13, v14
  ds_read_b64_tr_b16 v[216:217], v13 offset:0
  ds_read_b64_tr_b16 v[218:219], v13 offset:128
  ds_read_b64_tr_b16 v[220:221], v13 offset:256
  ds_read_b64_tr_b16 v[222:223], v13 offset:384
  v_pk_add_f32 v[176:177], v[176:177], v[20:21] op_sel_hi:[1,0]
  v_pk_add_f32 v[178:179], v[178:179], v[20:21] op_sel_hi:[1,0]
  v_pk_add_f32 v[180:181], v[180:181], v[20:21] op_sel_hi:[1,0]
  v_pk_add_f32 v[182:183], v[182:183], v[20:21] op_sel_hi:[1,0]
  v_pk_add_f32 v[184:185], v[184:185], v[20:21] op_sel_hi:[1,0]
  v_pk_add_f32 v[186:187], v[186:187], v[20:21] op_sel_hi:[1,0]
  v_pk_add_f32 v[188:189], v[188:189], v[20:21] op_sel_hi:[1,0]
  v_pk_add_f32 v[190:191], v[190:191], v[20:21] op_sel_hi:[1,0]
  v_exp_f32 v176, v176
  v_exp_f32 v177, v177
  v_exp_f32 v178, v178
  v_exp_f32 v179, v179
  v_exp_f32 v180, v180
  v_exp_f32 v181, v181
  v_exp_f32 v182, v182
  v_exp_f32 v183, v183
  v_exp_f32 v184, v184
  v_exp_f32 v185, v185
  v_exp_f32 v186, v186
  v_exp_f32 v187, v187
  v_exp_f32 v188, v188
  v_exp_f32 v189, v189
  v_exp_f32 v190, v190
  v_exp_f32 v191, v191
  v_cvt_pk_bf16_f32 v48, v176, v177
  v_cvt_pk_bf16_f32 v49, v178, v179
  v_cvt_pk_bf16_f32 v50, v180, v181
  v_cvt_pk_bf16_f32 v51, v182, v183
  v_cvt_pk_bf16_f32 v52, v184, v185
  v_cvt_pk_bf16_f32 v53, v186, v187
  v_cvt_pk_bf16_f32 v54, v188, v189
  v_cvt_pk_bf16_f32 v55, v190, v191
  s_waitcnt lgkmcnt(4)
  v_mfma_f32_32x32x16_bf16 v[32:47], v[208:211], v[48:51], v[32:47]
  v_mfma_f32_32x32x16_bf16 v[32:47], v[212:215], v[52:55], v[32:47]
  v_mov_b32 v13, v22
  ds_read_b64_tr_b16 v[224:225], v13 offset:0
  ds_read_b64_tr_b16 v[226:227], v13 offset:128
  ds_read_b64_tr_b16 v[228:229], v13 offset:256
  ds_read_b64_tr_b16 v[230:231], v13 offset:384
  v_pk_add_f32 v[192:193], v[192:193], v[20:21] op_sel_hi:[1,0]
  v_pk_add_f32 v[194:195], v[194:195], v[20:21] op_sel_hi:[1,0]
  v_pk_add_f32 v[196:197], v[196:197], v[20:21] op_sel_hi:[1,0]
  v_pk_add_f32 v[198:199], v[198:199], v[20:21] op_sel_hi:[1,0]
  v_pk_add_f32 v[200:201], v[200:201], v[20:21] op_sel_hi:[1,0]
  v_pk_add_f32 v[202:203], v[202:203], v[20:21] op_sel_hi:[1,0]
  v_pk_add_f32 v[204:205], v[204:205], v[20:21] op_sel_hi:[1,0]
  v_pk_add_f32 v[206:207], v[206:207], v[20:21] op_sel_hi:[1,0]
  v_exp_f32 v192, v192
  v_exp_f32 v193, v193
  v_exp_f32 v194, v194
  v_exp_f32 v195, v195
  v_exp_f32 v196, v196
  v_exp_f32 v197, v197
  v_exp_f32 v198, v198
  v_exp_f32 v199, v199
  v_exp_f32 v200, v200
  v_exp_f32 v201, v201
  v_exp_f32 v202, v202
  v_exp_f32 v203, v203
  v_exp_f32 v204, v204
  v_exp_f32 v205, v205
  v_exp_f32 v206, v206
  v_exp_f32 v207, v207
  v_cndmask_b32 v64, v192, 0, s[48:49]
  v_cndmask_b32 v192, 0, v192, s[48:49]
  v_cndmask_b32 v65, v193, 0, s[50:51]
  v_cndmask_b32 v193, 0, v193, s[50:51]
  v_cndmask_b32 v66, v194, 0, s[52:53]
  v_cndmask_b32 v194, 0, v194, s[52:53]
  v_cndmask_b32 v67, v195, 0, s[54:55]
  v_cndmask_b32 v195, 0, v195, s[54:55]
  v_cndmask_b32 v68, v196, 0, s[56:57]
  v_cndmask_b32 v196, 0, v196, s[56:57]
  v_cndmask_b32 v69, v197, 0, s[58:59]
  v_cndmask_b32 v197, 0, v197, s[58:59]
  v_cndmask_b32 v70, v198, 0, s[60:61]
  v_cndmask_b32 v198, 0, v198, s[60:61]
  v_cndmask_b32 v71, v199, 0, s[62:63]
  v_cndmask_b32 v199, 0, v199, s[62:63]
  v_cndmask_b32 v72, v200, 0, s[64:65]
  v_cndmask_b32 v200, 0, v200, s[64:65]
  v_cndmask_b32 v73, v201, 0, s[66:67]
  v_cndmask_b32 v201, 0, v201, s[66:67]
  v_cndmask_b32 v74, v202, 0, s[68:69]
  v_cndmask_b32 v202, 0, v202, s[68:69]
  v_cndmask_b32 v75, v203, 0, s[70:71]
  v_cndmask_b32 v203, 0, v203, s[70:71]
  v_cndmask_b32 v76, v204, 0, s[72:73]
  v_cndmask_b32 v204, 0, v204, s[72:73]
  v_cndmask_b32 v77, v205, 0, s[74:75]
  v_cndmask_b32 v205, 0, v205, s[74:75]
  v_cndmask_b32 v78, v206, 0, s[76:77]
  v_cndmask_b32 v206, 0, v206, s[76:77]
  v_cndmask_b32 v79, v207, 0, s[78:79]
  v_cndmask_b32 v207, 0, v207, s[78:79]
  v_cvt_pk_bf16_f32 v56, v192, v193
  v_cvt_pk_bf16_f32 v57, v194, v195
  v_cvt_pk_bf16_f32 v58, v196, v197
  v_cvt_pk_bf16_f32 v59, v198, v199
  v_cvt_pk_bf16_f32 v60, v200, v201
  v_cvt_pk_bf16_f32 v61, v202, v203
  v_cvt_pk_bf16_f32 v62, v204, v205
  v_cvt_pk_bf16_f32 v63, v206, v207
  s_waitcnt lgkmcnt(4)
  v_mfma_f32_32x32x16_bf16 v[32:47], v[216:219], v[56:59], v[32:47]
  v_mfma_f32_32x32x16_bf16 v[32:47], v[220:223], v[60:63], v[32:47]
  v_cvt_pk_bf16_f32 v48, v64, v65
  v_cvt_pk_bf16_f32 v49, v66, v67
  v_cvt_pk_bf16_f32 v50, v68, v69
  v_cvt_pk_bf16_f32 v51, v70, v71
  v_cvt_pk_bf16_f32 v52, v72, v73
  v_cvt_pk_bf16_f32 v53, v74, v75
  v_cvt_pk_bf16_f32 v54, v76, v77
  v_cvt_pk_bf16_f32 v55, v78, v79
  s_waitcnt lgkmcnt(0)
  v_mfma_f32_32x32x16_bf16 v[32:47], v[224:227], v[48:51], v[32:47]
  v_mfma_f32_32x32x16_bf16 v[32:47], v[228:231], v[52:55], v[32:47]
  v_add_u32 v12, 12288, v12
  v_add_u32 v23, 4096, v23
  v_mul_u32_u24 v16, 12, v14
  v_add_u32 v22, v22, v16
  s_nop 7
  v_rcp_f32 v16, v40
  s_nop 0
  v_pk_mul_f32 v[32:33], v[32:33], v[16:17] op_sel_hi:[1,0]
  v_pk_mul_f32 v[34:35], v[34:35], v[16:17] op_sel_hi:[1,0]
  v_pk_mul_f32 v[36:37], v[36:37], v[16:17] op_sel_hi:[1,0]
  v_pk_mul_f32 v[38:39], v[38:39], v[16:17] op_sel_hi:[1,0]
  v_cvt_pk_bf16_f32 v48, v32, v33
  v_cvt_pk_bf16_f32 v49, v34, v35
  v_cvt_pk_bf16_f32 v50, v36, v37
  v_cvt_pk_bf16_f32 v51, v38, v39
  s_cmp_eq_u32 s7, 0
  s_cbranch_scc1 SLOW_38
  buffer_store_dwordx4 v[48:51], v1, s[28:31], s89 offen
  s_branch SDONE_39
SLOW_38:
  buffer_store_dwordx4 v[48:51], v1, s[28:31], s89 offen sc1
SDONE_39:
  s_add_u32 s89, s89, 1024
  s_add_u32 s88, s88, 1
  s_cmp_lt_u32 s88, 2
  s_cbranch_scc1 L_UNIT
  s_lshl_b32 s80, s6, 8
  s_lshl_b32 s83, s5, 2
  s_add_u32 s80, s80, s83
  s_add_u32 s80, s80, s47
  s_add_u32 s80, s80, 0
  s_add_u32 s81, s80, 128
  s_waitcnt vmcnt(0)
  v_mov_b32 v16, s46
  s_mov_b64 exec, 1
  s_cmp_eq_u32 s7, 0
  s_cbranch_scc1 SLOW_40
  buffer_store_dword v16, off, s[28:31], s80
  buffer_store_dword v16, off, s[28:31], s81
  s_branch SDONE_41
SLOW_40:
  buffer_store_dword v16, off, s[28:31], s80 sc1
  buffer_store_dword v16, off, s[28:31], s81 sc1
SDONE_41:
  s_mov_b64 exec, -1
  s_barrier
  v_lshrrev_b32 v16, 5, v0
  v_lshlrev_b32 v16, 2, v16
  v_and_b32 v17, 15, v0
  v_lshrrev_b32 v17, 2, v17
  v_add_u32 v16, v16, v17
  v_lshlrev_b32 v16, 7, v16
  v_lshrrev_b32 v17, 1, v17
  s_lshr_b32 s80, s6, 1
  v_xor_b32 v17, s80, v17
  v_and_b32 v17, 1, v17
  v_lshlrev_b32 v17, 6, v17
  v_add_u32 v16, v16, v17
  v_lshrrev_b32 v17, 4, v0
  v_and_b32 v17, 1, v17
  v_lshlrev_b32 v17, 5, v17
  v_add_u32 v16, v16, v17
  v_and_b32 v17, 3, v0
  v_lshlrev_b32 v17, 3, v17
  v_add_u32 v16, v16, v17
  s_lshl_b32 s80, s80, 11
  v_add_u32 v12, s80, v16
  v_xor_b32 v13, 64, v12
  s_lshr_b32 s87, s5, 3
  s_lshl_b32 s87, s87, 1
  s_and_b32 s86, s6, 1
  s_add_u32 s87, s87, s86
  s_lshl_b32 s86, s4, 2
  s_add_u32 s86, s86, s87
  s_and_b32 s80, s6, 1
  s_lshl_b32 s80, s80, 1
  s_lshr_b32 s81, s6, 1
  s_add_u32 s80, s80, s81
  s_lshl_b32 s80, s80, 12
  s_add_u32 s80, s80, 32768
  v_add_u32 v24, s80, v1
  v_xor_b32 v25, 0x1000, v24
  s_lshl_b32 s82, s3, 19
  s_add_u32 s82, s82, 524288
  s_lshl_b32 s89, s86, 12
  s_add_u32 s89, s89, s82
  s_and_b32 s81, s5, 7
  s_lshl_b32 s81, s81, 9
  s_add_u32 s89, s89, s81
  s_lshr_b32 s81, s6, 1
  s_lshl_b32 s81, s81, 3
  s_add_u32 s89, s89, s81
  s_lshl_b32 s90, s87, 7
  s_add_u32 s90, s90, s47
  s_and_b32 s81, s5, 7
  s_lshl_b32 s81, s81, 3
  s_add_u32 s90, s90, s81
  s_lshr_b32 s81, s6, 1
  s_lshl_b32 s81, s81, 2
  s_add_u32 s90, s90, s81
  s_add_u32 s90, s90, 1024
  v_and_b32 v26, 15, v0
  v_lshlrev_b32 v26, 4, v26
  v_lshrrev_b32 v21, 4, v0
  v_and_b32 v21, 1, v21
  v_lshlrev_b32 v21, 14, v21
  v_add_u32 v26, v26, v21
  v_lshrrev_b32 v21, 5, v0
  v_lshlrev_b32 v21, 8, v21
  v_add_u32 v26, v26, v21
  s_lshl_b32 s88, s86, 15
  s_lshl_b32 s81, s3, 21
  s_add_u32 s88, s88, s81
  s_and_b32 s81, s5, 7
  s_lshl_b32 s81, s81, 11
  s_add_u32 s88, s88, s81
  s_lshr_b32 s81, s6, 1
  s_lshl_b32 s81, s81, 10
  s_add_u32 s88, s88, s81
  s_add_u32 s88, s88, 6291456
  s_lshl_b32 s80, s87, 1
  s_lshr_b32 s81, s6, 1
  s_add_u32 s80, s80, s81
  s_lshl_b32 s80, s80, 7
  s_add_u32 s80, s80, s47
  s_add_u32 s80, s80, 0
  s_mov_b32 s99, 0
POLL_42:
  buffer_load_dword v16, v10, s[28:31], s80 offen sc1
  s_add_u32 s99, s99, 1
  s_cmp_gt_u32 s99, 100000
  s_cbranch_scc1 L_BAIL
  s_waitcnt vmcnt(0)
  v_cmp_gt_u32 vcc, s46, v16
  s_cbranch_vccnz POLL_42
POLLOK_43:
  s_lshl_b32 s80, s86, 15
  s_lshl_b32 s81, s3, 21
  s_add_u32 s80, s80, s81
  s_lshr_b32 s81, s6, 1
  s_lshl_b32 s81, s81, 10
  s_add_u32 s80, s80, s81
  s_add_u32 s80, s80, 10485760
  s_mov_b32 s85, s80
  buffer_load_dwordx4 v[128:131], v1, s[28:31], s85 offen offset:0 sc1
  buffer_load_dwordx4 v[132:135], v1, s[28:31], s85 offen offset:2048 sc1
  s_add_u32 s85, s85, 4096
  buffer_load_dwordx4 v[136:139], v1, s[28:31], s85 offen offset:0 sc1
  buffer_load_dwordx4 v[140:143], v1, s[28:31], s85 offen offset:2048 sc1
  s_add_u32 s85, s85, 4096
  buffer_load_dwordx4 v[144:147], v1, s[28:31], s85 offen offset:0 sc1
  buffer_load_dwordx4 v[148:151], v1, s[28:31], s85 offen offset:2048 sc1
  s_add_u32 s85, s85, 4096
  buffer_load_dwordx4 v[152:155], v1, s[28:31], s85 offen offset:0 sc1
  buffer_load_dwordx4 v[156:159], v1, s[28:31], s85 offen offset:2048 sc1
  s_add_u32 s85, s85, 4096
  buffer_load_dwordx4 v[160:163], v1, s[28:31], s85 offen offset:0 sc1
  buffer_load_dwordx4 v[164:167], v1, s[28:31], s85 offen offset:2048 sc1
  s_add_u32 s85, s85, 4096
  ds_read_b64_tr_b16 v[48:49], v12 offset:0
  ds_read_b64_tr_b16 v[50:51], v12 offset:1024
  ds_read_b64_tr_b16 v[52:53], v13 offset:0
  ds_read_b64_tr_b16 v[54:55], v13 offset:1024
  ds_read_b64_tr_b16 v[56:57], v12 offset:4096
  ds_read_b64_tr_b16 v[58:59], v12 offset:5120
  ds_read_b64_tr_b16 v[60:61], v13 offset:4096
  ds_read_b64_tr_b16 v[62:63], v13 offset:5120
  ds_read_b64_tr_b16 v[64:65], v12 offset:8192
  ds_read_b64_tr_b16 v[66:67], v12 offset:9216
  ds_read_b64_tr_b16 v[68:69], v13 offset:8192
  ds_read_b64_tr_b16 v[70:71], v13 offset:9216
  s_waitcnt vmcnt(9) lgkmcnt(8)
  v_mfma_f32_32x32x16_bf16 v[80:95], v[48:51], v[128:131], 0
  ds_read_b64_tr_b16 v[72:73], v12 offset:12288
  ds_read_b64_tr_b16 v[74:75], v12 offset:13312
  ds_read_b64_tr_b16 v[76:77], v13 offset:12288
  ds_read_b64_tr_b16 v[78:79], v13 offset:13312
  v_mfma_f32_32x32x16_bf16 v[96:111], v[52:55], v[128:131], 0
  buffer_load_dwordx4 v[168:171], v1, s[28:31], s85 offen offset:0 sc1
  s_waitcnt vmcnt(9) lgkmcnt(8)
  v_mfma_f32_32x32x16_bf16 v[80:95], v[56:59], v[132:135], v[80:95]
  ds_read_b64_tr_b16 v[48:49], v12 offset:16384
  ds_read_b64_tr_b16 v[50:51], v12 offset:17408
  ds_read_b64_tr_b16 v[52:53], v13 offset:16384
  ds_read_b64_tr_b16 v[54:55], v13 offset:17408
  v_mfma_f32_32x32x16_bf16 v[96:111], v[60:63], v[132:135], v[96:111]
  buffer_load_dwordx4 v[172:175], v1, s[28:31], s85 offen offset:2048 sc1
  s_add_u32 s85, s85, 4096
  s_waitcnt vmcnt(9) lgkmcnt(8)
  v_mfma_f32_32x32x16_bf16 v[80:95], v[64:67], v[136:139], v[80:95]
  ds_read_b64_tr_b16 v[56:57], v12 offset:20480
  ds_read_b64_tr_b16 v[58:59], v12 offset:21504
  ds_read_b64_tr_b16 v[60:61], v13 offset:20480
  ds_read_b64_tr_b16 v[62:63], v13 offset:21504
  v_mfma_f32_32x32x16_bf16 v[96:111], v[68:71], v[136:139], v[96:111]
  buffer_load_dwordx4 v[176:179], v1, s[28:31], s85 offen offset:0 sc1
  s_waitcnt vmcnt(9) lgkmcnt(8)
  v_mfma_f32_32x32x16_bf16 v[80:95], v[72:75], v[140:143], v[80:95]
  ds_read_b64_tr_b16 v[64:65], v12 offset:24576
  ds_read_b64_tr_b16 v[66:67], v12 offset:25600
  ds_read_b64_tr_b16 v[68:69], v13 offset:24576
  ds_read_b64_tr_b16 v[70:71], v13 offset:25600
  v_mfma_f32_32x32x16_bf16 v[96:111], v[76:79], v[140:143], v[96:111]
  buffer_load_dwordx4 v[180:183], v1, s[28:31], s85 offen offset:2048 sc1
  s_add_u32 s85, s85, 4096
  s_waitcnt vmcnt(9) lgkmcnt(8)
  v_mfma_f32_32x32x16_bf16 v[80:95], v[48:51], v[144:147], v[80:95]
  ds_read_b64_tr_b16 v[72:73], v12 offset:28672
  ds_read_b64_tr_b16 v[74:75], v12 offset:29696
  ds_read_b64_tr_b16 v[76:77], v13 offset:28672
  ds_read_b64_tr_b16 v[78:79], v13 offset:29696
  v_mfma_f32_32x32x16_bf16 v[96:111], v[52:55], v[144:147], v[96:111]
  buffer_load_dwordx4 v[184:187], v1, s[28:31], s85 offen offset:0 sc1
  s_waitcnt vmcnt(9) lgkmcnt(8)
  v_mfma_f32_32x32x16_bf16 v[80:95], v[56:59], v[148:151], v[80:95]
  ds_read_b64_tr_b16 v[48:49], v12 offset:32768
  ds_read_b64_tr_b16 v[50:51], v12 offset:33792
  ds_read_b64_tr_b16 v[52:53], v13 offset:32768
  ds_read_b64_tr_b16 v[54:55], v13 offset:33792
  v_mfma_f32_32x32x16_bf16 v[96:111], v[60:63], v[148:151], v[96:111]
  buffer_load_dwordx4 v[188:191], v1, s[28:31], s85 offen offset:2048 sc1
  s_add_u32 s85, s85, 4096
  s_waitcnt vmcnt(9) lgkmcnt(8)
  v_mfma_f32_32x32x16_bf16 v[80:95], v[64:67], v[152:155], v[80:95]
  ds_read_b64_tr_b16 v[56:57], v12 offset:36864
  ds_read_b64_tr_b16 v[58:59], v12 offset:37888
  ds_read_b64_tr_b16 v[60:61], v13 offset:36864
  ds_read_b64_tr_b16 v[62:63], v13 offset:37888
  v_mfma_f32_32x32x16_bf16 v[96:111], v[68:71], v[152:155], v[96:111]
  s_waitcnt vmcnt(8) lgkmcnt(8)
  v_mfma_f32_32x32x16_bf16 v[80:95], v[72:75], v[156:159], v[80:95]
  ds_read_b64_tr_b16 v[64:65], v12 offset:40960
  ds_read_b64_tr_b16 v[66:67], v12 offset:41984
  ds_read_b64_tr_b16 v[68:69], v13 offset:40960
  ds_read_b64_tr_b16 v[70:71], v13 offset:41984
  v_mfma_f32_32x32x16_bf16 v[96:111], v[76:79], v[156:159], v[96:111]
  s_waitcnt vmcnt(7) lgkmcnt(8)
  v_mfma_f32_32x32x16_bf16 v[80:95], v[48:51], v[160:163], v[80:95]
  ds_read_b64_tr_b16 v[72:73], v12 offset:45056
  ds_read_b64_tr_b16 v[74:75], v12 offset:46080
  ds_read_b64_tr_b16 v[76:77], v13 offset:45056
  ds_read_b64_tr_b16 v[78:79], v13 offset:46080
  v_mfma_f32_32x32x16_bf16 v[96:111], v[52:55], v[160:163], v[96:111]
  s_waitcnt vmcnt(6) lgkmcnt(8)
  v_mfma_f32_32x32x16_bf16 v[80:95], v[56:59], v[164:167], v[80:95]
  ds_read_b64_tr_b16 v[48:49], v12 offset:49152
  ds_read_b64_tr_b16 v[50:51], v12 offset:50176
  ds_read_b64_tr_b16 v[52:53], v13 offset:49152
  ds_read_b64_tr_b16 v[54:55], v13 offset:50176
  v_mfma_f32_32x32x16_bf16 v[96:111], v[60:63], v[164:167], v[96:111]
  s_waitcnt vmcnt(5) lgkmcnt(8)
  v_mfma_f32_32x32x16_bf16 v[80:95], v[64:67], v[168:171], v[80:95]
  ds_read_b64_tr_b16 v[56:57], v12 offset:53248
  ds_read_b64_tr_b16 v[58:59], v12 offset:54272
  ds_read_b64_tr_b16 v[60:61], v13 offset:53248
  ds_read_b64_tr_b16 v[62:63], v13 offset:54272
  v_mfma_f32_32x32x16_bf16 v[96:111], v[68:71], v[168:171], v[96:111]
  s_waitcnt vmcnt(4) lgkmcnt(8)
  v_mfma_f32_32x32x16_bf16 v[80:95], v[72:75], v[172:175], v[80:95]
  ds_read_b64_tr_b16 v[64:65], v12 offset:57344
  ds_read_b64_tr_b16 v[66:67], v12 offset:58368
  ds_read_b64_tr_b16 v[68:69], v13 offset:57344
  ds_read_b64_tr_b16 v[70:71], v13 offset:58368
  v_mfma_f32_32x32x16_bf16 v[96:111], v[76:79], v[172:175], v[96:111]
  s_waitcnt vmcnt(3) lgkmcnt(8)
  v_mfma_f32_32x32x16_bf16 v[80:95], v[48:51], v[176:179], v[80:95]
  ds_read_b64_tr_b16 v[72:73], v12 offset:61440
  ds_read_b64_tr_b16 v[74:75], v12 offset:62464
  ds_read_b64_tr_b16 v[76:77], v13 offset:61440
  ds_read_b64_tr_b16 v[78:79], v13 offset:62464
  v_mfma_f32_32x32x16_bf16 v[96:111], v[52:55], v[176:179], v[96:111]
  s_waitcnt vmcnt(2) lgkmcnt(8)
  v_mfma_f32_32x32x16_bf16 v[80:95], v[56:59], v[180:183], v[80:95]
  v_mfma_f32_32x32x16_bf16 v[96:111], v[60:63], v[180:183], v[96:111]
  s_waitcnt vmcnt(1) lgkmcnt(4)
  v_mfma_f32_32x32x16_bf16 v[80:95], v[64:67], v[184:187], v[80:95]
  v_mfma_f32_32x32x16_bf16 v[96:111], v[68:71], v[184:187], v[96:111]
  s_waitcnt vmcnt(0) lgkmcnt(0)
  v_mfma_f32_32x32x16_bf16 v[80:95], v[72:75], v[188:191], v[80:95]
  v_mfma_f32_32x32x16_bf16 v[96:111], v[76:79], v[188:191], v[96:111]
  s_barrier
  s_nop 10
  ds_write_b128 v25, v[96:99] offset:0
  ds_write_b128 v25, v[100:103] offset:1024
  ds_write_b128 v25, v[104:107] offset:2048
  ds_write_b128 v25, v[108:111] offset:3072
  v_lshlrev_b32 v112, 16, v2
  v_and_b32 v113, 0xffff0000, v2
  v_lshlrev_b32 v114, 16, v3
  v_and_b32 v115, 0xffff0000, v3
  v_lshlrev_b32 v116, 16, v4
  v_and_b32 v117, 0xffff0000, v4
  v_lshlrev_b32 v118, 16, v5
  v_and_b32 v119, 0xffff0000, v5
  v_lshlrev_b32 v120, 16, v6
  v_and_b32 v121, 0xffff0000, v6
  v_lshlrev_b32 v122, 16, v7
  v_and_b32 v123, 0xffff0000, v7
  v_lshlrev_b32 v124, 16, v8
  v_and_b32 v125, 0xffff0000, v8
  v_lshlrev_b32 v126, 16, v9
  v_and_b32 v127, 0xffff0000, v9
  v_pk_add_f32 v[80:81], v[80:81], v[112:113]
  v_pk_add_f32 v[82:83], v[82:83], v[114:115]
  v_pk_add_f32 v[84:85], v[84:85], v[116:117]
  v_pk_add_f32 v[86:87], v[86:87], v[118:119]
  v_pk_add_f32 v[88:89], v[88:89], v[120:121]
  v_pk_add_f32 v[90:91], v[90:91], v[122:123]
  v_pk_add_f32 v[92:93], v[92:93], v[124:125]
  v_pk_add_f32 v[94:95], v[94:95], v[126:127]
  s_waitcnt lgkmcnt(0)
  s_barrier
  ds_read_b128 v[112:115], v24 offset:0
  ds_read_b128 v[116:119], v24 offset:1024
  ds_read_b128 v[120:123], v24 offset:2048
  ds_read_b128 v[124:127], v24 offset:3072
  s_waitcnt lgkmcnt(3)
  v_pk_add_f32 v[80:81], v[80:81], v[112:113]
  v_pk_add_f32 v[82:83], v[82:83], v[114:115]
  s_waitcnt lgkmcnt(2)
  v_pk_add_f32 v[84:85], v[84:85], v[116:117]
  v_pk_add_f32 v[86:87], v[86:87], v[118:119]
  s_waitcnt lgkmcnt(1)
  v_pk_add_f32 v[88:89], v[88:89], v[120:121]
  v_pk_add_f32 v[90:91], v[90:91], v[122:123]
  s_waitcnt lgkmcnt(0)
  v_pk_add_f32 v[92:93], v[92:93], v[124:125]
  v_pk_add_f32 v[94:95], v[94:95], v[126:127]
  v_cvt_pk_bf16_f32 v2, v80, v81
  v_cvt_pk_bf16_f32 v3, v82, v83
  v_cvt_pk_bf16_f32 v4, v84, v85
  v_cvt_pk_bf16_f32 v5, v86, v87
  v_cvt_pk_bf16_f32 v6, v88, v89
  v_cvt_pk_bf16_f32 v7, v90, v91
  v_cvt_pk_bf16_f32 v8, v92, v93
  v_cvt_pk_bf16_f32 v9, v94, v95
  v_pk_add_f32 v[112:113], v[80:81], v[82:83]
  v_pk_mul_f32 v[114:115], v[80:81], v[80:81]
  v_pk_fma_f32 v[114:115], v[82:83], v[82:83], v[114:115]
  v_pk_add_f32 v[112:113], v[112:113], v[84:85]
  v_pk_fma_f32 v[114:115], v[84:85], v[84:85], v[114:115]
  v_pk_add_f32 v[112:113], v[112:113], v[86:87]
  v_pk_fma_f32 v[114:115], v[86:87], v[86:87], v[114:115]
  v_pk_add_f32 v[112:113], v[112:113], v[88:89]
  v_pk_fma_f32 v[114:115], v[88:89], v[88:89], v[114:115]
  v_pk_add_f32 v[112:113], v[112:113], v[90:91]
  v_pk_fma_f32 v[114:115], v[90:91], v[90:91], v[114:115]
  v_pk_add_f32 v[112:113], v[112:113], v[92:93]
  v_pk_fma_f32 v[114:115], v[92:93], v[92:93], v[114:115]
  v_pk_add_f32 v[112:113], v[112:113], v[94:95]
  v_pk_fma_f32 v[114:115], v[94:95], v[94:95], v[114:115]
  v_add_f32 v16, v112, v113
  v_add_f32 v17, v114, v115
  v_mov_b32 v18, v16
  v_mov_b32 v19, v17
  s_nop 0
  v_permlane32_swap_b32 v16, v18
  v_permlane32_swap_b32 v17, v19
  v_add_f32 v16, v16, v18
  v_add_f32 v17, v17, v19
  s_cmp_eq_u32 s7, 0
  s_cbranch_scc1 SLOW_44
  buffer_store_dwordx4 v[2:5], v26, s[28:31], s88 offen
  buffer_store_dwordx4 v[6:9], v26, s[28:31], s88 offen offset:512
  s_branch SDONE_45
SLOW_44:
  buffer_store_dwordx4 v[2:5], v26, s[28:31], s88 offen sc1
  buffer_store_dwordx4 v[6:9], v26, s[28:31], s88 offen offset:512 sc1
SDONE_45:
  s_mov_b32 exec_hi, 0
  s_cmp_eq_u32 s7, 0
  s_cbranch_scc1 SLOW_46
  buffer_store_dwordx2 v[16:17], v1, s[28:31], s89 offen
  s_branch SDONE_47
SLOW_46:
  buffer_store_dwordx2 v[16:17], v1, s[28:31], s89 offen sc1
SDONE_47:
  s_mov_b32 exec_hi, -1
  s_waitcnt vmcnt(0)
  v_mov_b32 v18, s46
  s_mov_b64 exec, 1
  s_cmp_eq_u32 s7, 0
  s_cbranch_scc1 SLOW_48
  buffer_store_dword v18, off, s[28:31], s90
  s_branch SDONE_49
SLOW_48:
  buffer_store_dword v18, off, s[28:31], s90 sc1
SDONE_49:
  s_mov_b64 exec, -1
  s_barrier
  v_lshrrev_b32 v16, 4, v0
  v_and_b32 v17, 1, v16
  v_lshlrev_b32 v17, 2, v17
  v_lshrrev_b32 v16, 1, v16
  v_lshlrev_b32 v16, 4, v16
  v_add_u32 v16, v16, v17
  v_and_b32 v17, 15, v0
  v_lshrrev_b32 v17, 2, v17
  v_add_u32 v16, v16, v17
  v_mul_u32_u24 v16, 224, v16
  v_and_b32 v17, 3, v0
  v_lshlrev_b32 v17, 3, v17
  v_add_u32 v12, v16, v17
  v_add_u32 v13, 0x10000, v12
  v_add_u32 v14, 0x20000, v12
  s_lshl_b32 s86, s4, 2
  s_add_u32 s86, s86, s6
  s_lshl_b32 s80, s6, 7
  s_add_u32 s80, s80, s47
  s_add_u32 s80, s80, 1024
  s_mov_b32 s99, 0
POLL_50:
  buffer_load_dword v16, v10, s[28:31], s80 offen sc1
  s_add_u32 s99, s99, 1
  s_cmp_gt_u32 s99, 100000
  s_cbranch_scc1 L_BAIL
  s_waitcnt vmcnt(0)
  v_cmp_gt_u32 vcc, s46, v16
  s_cbranch_vccnz POLL_50
POLLOK_51:
  s_lshl_b32 s85, s86, 15
  s_lshl_b32 s81, s3, 21
  s_add_u32 s85, s85, s81
  s_add_u32 s85, s85, 6291456
  s_add_u32 s84, s85, 16384
  buffer_load_dwordx4 v[128:131], v1, s[28:31], s85 offen offset:0 sc1
  buffer_load_dwordx4 v[132:135], v1, s[28:31], s84 offen offset:0 sc1
  buffer_load_dwordx4 v[136:139], v1, s[28:31], s85 offen offset:1024 sc1
  buffer_load_dwordx4 v[140:143], v1, s[28:31], s84 offen offset:1024 sc1
  buffer_load_dwordx4 v[144:147], v1, s[28:31], s85 offen offset:2048 sc1
  buffer_load_dwordx4 v[148:151], v1, s[28:31], s84 offen offset:2048 sc1
  buffer_load_dwordx4 v[152:155], v1, s[28:31], s85 offen offset:3072 sc1
  buffer_load_dwordx4 v[156:159], v1, s[28:31], s84 offen offset:3072 sc1
  s_add_u32 s85, s85, 4096
  s_add_u32 s84, s84, 4096
  s_lshl_b32 s83, s86, 12
  s_lshl_b32 s81, s3, 19
  s_add_u32 s83, s83, s81
  s_add_u32 s83, s83, 524288
  v_lshrrev_b32 v70, 4, v0
  v_and_b32 v70, 1, v70
  v_lshlrev_b32 v70, 9, v70
  v_lshrrev_b32 v71, 5, v0
  v_lshlrev_b32 v71, 8, v71
  v_add_u32 v70, v70, v71
  v_and_b32 v71, 15, v0
  v_lshlrev_b32 v71, 4, v71
  v_add_u32 v15, v70, v71
  s_mul_i32 s88, s86, 114688
  s_mul_i32 s81, s3, 7340032
  s_add_u32 s88, s88, s81
  s_mul_i32 s81, s5, 7168
  s_add_u32 s88, s88, s81
  s_add_u32 s88, s88, 23068672
  s_add_u32 s89, s88, 4096
  s_lshl_b32 s90, s6, 7
  s_lshl_b32 s81, s5, 2
  s_add_u32 s90, s90, s81
  s_add_u32 s90, s90, s47
  s_add_u32 s90, s90, 1536
  s_barrier
  ds_read_b64_tr_b16 v[32:33], v13 offset:0
  ds_read_b64_tr_b16 v[34:35], v13 offset:1792
  ds_read_b64_tr_b16 v[36:37], v13 offset:32
  ds_read_b64_tr_b16 v[38:39], v13 offset:1824
  ds_read_b64_tr_b16 v[40:41], v13 offset:64
  ds_read_b64_tr_b16 v[42:43], v13 offset:1856
  ds_read_b64_tr_b16 v[44:45], v13 offset:96
  ds_read_b64_tr_b16 v[46:47], v13 offset:1888
  ds_read_b64_tr_b16 v[48:49], v13 offset:128
  ds_read_b64_tr_b16 v[50:51], v13 offset:1920
  ds_read_b64_tr_b16 v[52:53], v13 offset:160
  ds_read_b64_tr_b16 v[54:55], v13 offset:1952
  ds_read_b64_tr_b16 v[56:57], v13 offset:192
  ds_read_b64_tr_b16 v[58:59], v13 offset:1984
  s_waitcnt vmcnt(6) lgkmcnt(12)
  v_mfma_f32_16x16x32_bf16 v[72:75], v[32:35], v[128:131], 0
  ds_read_b64_tr_b16 v[60:61], v13 offset:7168
  ds_read_b64_tr_b16 v[62:63], v13 offset:8960
  v_mfma_f32_16x16x32_bf16 v[76:79], v[32:35], v[132:135], 0
  s_waitcnt lgkmcnt(12)
  v_mfma_f32_16x16x32_bf16 v[80:83], v[36:39], v[128:131], 0
  ds_read_b64_tr_b16 v[64:65], v13 offset:7200
  ds_read_b64_tr_b16 v[66:67], v13 offset:8992
  v_mfma_f32_16x16x32_bf16 v[84:87], v[36:39], v[132:135], 0
  buffer_load_dwordx4 v[160:163], v1, s[28:31], s85 offen offset:0 sc1
  buffer_load_dwordx4 v[164:167], v1, s[28:31], s84 offen offset:0 sc1
  buffer_load_dwordx4 v[168:171], v1, s[28:31], s85 offen offset:1024 sc1
  buffer_load_dwordx4 v[172:175], v1, s[28:31], s84 offen offset:1024 sc1
  s_waitcnt lgkmcnt(12)
  v_mfma_f32_16x16x32_bf16 v[88:91], v[40:43], v[128:131], 0
  ds_read_b64_tr_b16 v[32:33], v13 offset:7232
  ds_read_b64_tr_b16 v[34:35], v13 offset:9024
  v_mfma_f32_16x16x32_bf16 v[92:95], v[40:43], v[132:135], 0
  s_waitcnt lgkmcnt(12)
  v_mfma_f32_16x16x32_bf16 v[96:99], v[44:47], v[128:131], 0
  ds_read_b64_tr_b16 v[36:37], v13 offset:7264
  ds_read_b64_tr_b16 v[38:39], v13 offset:9056
  v_mfma_f32_16x16x32_bf16 v[100:103], v[44:47], v[132:135], 0
  s_waitcnt lgkmcnt(12)
  v_mfma_f32_16x16x32_bf16 v[104:107], v[48:51], v[128:131], 0
  ds_read_b64_tr_b16 v[40:41], v13 offset:7296
  ds_read_b64_tr_b16 v[42:43], v13 offset:9088
  v_mfma_f32_16x16x32_bf16 v[108:111], v[48:51], v[132:135], 0
  s_waitcnt lgkmcnt(12)
  v_mfma_f32_16x16x32_bf16 v[112:115], v[52:55], v[128:131], 0
  ds_read_b64_tr_b16 v[44:45], v13 offset:7328
  ds_read_b64_tr_b16 v[46:47], v13 offset:9120
  v_mfma_f32_16x16x32_bf16 v[116:119], v[52:55], v[132:135], 0
  s_waitcnt lgkmcnt(12)
  v_mfma_f32_16x16x32_bf16 v[120:123], v[56:59], v[128:131], 0
  ds_read_b64_tr_b16 v[48:49], v13 offset:7360
  ds_read_b64_tr_b16 v[50:51], v13 offset:9152
  v_mfma_f32_16x16x32_bf16 v[124:127], v[56:59], v[132:135], 0
  s_waitcnt vmcnt(8) lgkmcnt(12)
  v_mfma_f32_16x16x32_bf16 v[72:75], v[60:63], v[136:139], v[72:75]
  ds_read_b64_tr_b16 v[52:53], v13 offset:14336
  ds_read_b64_tr_b16 v[54:55], v13 offset:16128
  v_mfma_f32_16x16x32_bf16 v[76:79], v[60:63], v[140:143], v[76:79]
  s_waitcnt lgkmcnt(12)
  v_mfma_f32_16x16x32_bf16 v[80:83], v[64:67], v[136:139], v[80:83]
  ds_read_b64_tr_b16 v[56:57], v13 offset:14368
  ds_read_b64_tr_b16 v[58:59], v13 offset:16160
  v_mfma_f32_16x16x32_bf16 v[84:87], v[64:67], v[140:143], v[84:87]
  buffer_load_dwordx4 v[176:179], v1, s[28:31], s85 offen offset:2048 sc1
  buffer_load_dwordx4 v[180:183], v1, s[28:31], s84 offen offset:2048 sc1
  buffer_load_dwordx4 v[184:187], v1, s[28:31], s85 offen offset:3072 sc1
  buffer_load_dwordx4 v[188:191], v1, s[28:31], s84 offen offset:3072 sc1
  s_add_u32 s85, s85, 4096
  s_add_u32 s84, s84, 4096
  s_waitcnt lgkmcnt(12)
  v_mfma_f32_16x16x32_bf16 v[88:91], v[32:35], v[136:139], v[88:91]
  ds_read_b64_tr_b16 v[60:61], v13 offset:14400
  ds_read_b64_tr_b16 v[62:63], v13 offset:16192
  v_mfma_f32_16x16x32_bf16 v[92:95], v[32:35], v[140:143], v[92:95]
  s_waitcnt lgkmcnt(12)
  v_mfma_f32_16x16x32_bf16 v[96:99], v[36:39], v[136:139], v[96:99]
  ds_read_b64_tr_b16 v[64:65], v13 offset:14432
  ds_read_b64_tr_b16 v[66:67], v13 offset:16224
  v_mfma_f32_16x16x32_bf16 v[100:103], v[36:39], v[140:143], v[100:103]
  s_waitcnt lgkmcnt(12)
  v_mfma_f32_16x16x32_bf16 v[104:107], v[40:43], v[136:139], v[104:107]
  ds_read_b64_tr_b16 v[32:33], v13 offset:14464
  ds_read_b64_tr_b16 v[34:35], v13 offset:16256
  v_mfma_f32_16x16x32_bf16 v[108:111], v[40:43], v[140:143], v[108:111]
  s_waitcnt lgkmcnt(12)
  v_mfma_f32_16x16x32_bf16 v[112:115], v[44:47], v[136:139], v[112:115]
  ds_read_b64_tr_b16 v[36:37], v13 offset:14496
  ds_read_b64_tr_b16 v[38:39], v13 offset:16288
  v_mfma_f32_16x16x32_bf16 v[116:119], v[44:47], v[140:143], v[116:119]
  s_waitcnt lgkmcnt(12)
  v_mfma_f32_16x16x32_bf16 v[120:123], v[48:51], v[136:139], v[120:123]
  ds_read_b64_tr_b16 v[40:41], v13 offset:14528
  ds_read_b64_tr_b16 v[42:43], v13 offset:16320
  v_mfma_f32_16x16x32_bf16 v[124:127], v[48:51], v[140:143], v[124:127]
  s_waitcnt vmcnt(10) lgkmcnt(12)
  v_mfma_f32_16x16x32_bf16 v[72:75], v[52:55], v[144:147], v[72:75]
  ds_read_b64_tr_b16 v[44:45], v13 offset:21504
  ds_read_b64_tr_b16 v[46:47], v13 offset:23296
  v_mfma_f32_16x16x32_bf16 v[76:79], v[52:55], v[148:151], v[76:79]
  s_waitcnt lgkmcnt(12)
  v_mfma_f32_16x16x32_bf16 v[80:83], v[56:59], v[144:147], v[80:83]
  ds_read_b64_tr_b16 v[48:49], v13 offset:21536
  ds_read_b64_tr_b16 v[50:51], v13 offset:23328
  v_mfma_f32_16x16x32_bf16 v[84:87], v[56:59], v[148:151], v[84:87]
  buffer_load_dwordx4 v[192:195], v1, s[28:31], s85 offen offset:0 sc1
  buffer_load_dwordx4 v[196:199], v1, s[28:31], s84 offen offset:0 sc1
  buffer_load_dwordx4 v[200:203], v1, s[28:31], s85 offen offset:1024 sc1
  buffer_load_dwordx4 v[204:207], v1, s[28:31], s84 offen offset:1024 sc1
  buffer_load_dwordx4 v[16:19], v1, s[28:31], s83 offen offset:0 sc1
  buffer_load_dwordx4 v[20:23], v1, s[28:31], s83 offen offset:1024 sc1
  buffer_load_dwordx4 v[24:27], v1, s[28:31], s83 offen offset:2048 sc1
  buffer_load_dwordx4 v[28:31], v1, s[28:31], s83 offen offset:3072 sc1
  s_waitcnt lgkmcnt(12)
  v_mfma_f32_16x16x32_bf16 v[88:91], v[60:63], v[144:147], v[88:91]
  ds_read_b64_tr_b16 v[52:53], v13 offset:21568
  ds_read_b64_tr_b16 v[54:55], v13 offset:23360
  v_mfma_f32_16x16x32_bf16 v[92:95], v[60:63], v[148:151], v[92:95]
  s_waitcnt lgkmcnt(12)
  v_mfma_f32_16x16x32_bf16 v[96:99], v[64:67], v[144:147], v[96:99]
  ds_read_b64_tr_b16 v[56:57], v13 offset:21600
  ds_read_b64_tr_b16 v[58:59], v13 offset:23392
  v_mfma_f32_16x16x32_bf16 v[100:103], v[64:67], v[148:151], v[100:103]
  s_waitcnt lgkmcnt(12)
  v_mfma_f32_16x16x32_bf16 v[104:107], v[32:35], v[144:147], v[104:107]
  ds_read_b64_tr_b16 v[60:61], v13 offset:21632
  ds_read_b64_tr_b16 v[62:63], v13 offset:23424
  v_mfma_f32_16x16x32_bf16 v[108:111], v[32:35], v[148:151], v[108:111]
  s_waitcnt lgkmcnt(12)
  v_mfma_f32_16x16x32_bf16 v[112:115], v[36:39], v[144:147], v[112:115]
  ds_read_b64_tr_b16 v[64:65], v13 offset:21664
  ds_read_b64_tr_b16 v[66:67], v13 offset:23456
  v_mfma_f32_16x16x32_bf16 v[116:119], v[36:39], v[148:151], v[116:119]
  s_waitcnt lgkmcnt(12)
  v_mfma_f32_16x16x32_bf16 v[120:123], v[40:43], v[144:147], v[120:123]
  ds_read_b64_tr_b16 v[32:33], v13 offset:21696
  ds_read_b64_tr_b16 v[34:35], v13 offset:23488
  v_mfma_f32_16x16x32_bf16 v[124:127], v[40:43], v[148:151], v[124:127]
  s_waitcnt vmcnt(16) lgkmcnt(12)
  v_mfma_f32_16x16x32_bf16 v[72:75], v[44:47], v[152:155], v[72:75]
  ds_read_b64_tr_b16 v[36:37], v13 offset:32768
  ds_read_b64_tr_b16 v[38:39], v13 offset:34560
  v_mfma_f32_16x16x32_bf16 v[76:79], v[44:47], v[156:159], v[76:79]
  s_waitcnt lgkmcnt(12)
  v_mfma_f32_16x16x32_bf16 v[80:83], v[48:51], v[152:155], v[80:83]
  ds_read_b64_tr_b16 v[40:41], v13 offset:32800
  ds_read_b64_tr_b16 v[42:43], v13 offset:34592
  v_mfma_f32_16x16x32_bf16 v[84:87], v[48:51], v[156:159], v[84:87]
  buffer_load_dwordx4 v[208:211], v1, s[28:31], s85 offen offset:2048 sc1
  buffer_load_dwordx4 v[212:215], v1, s[28:31], s84 offen offset:2048 sc1
  buffer_load_dwordx4 v[216:219], v1, s[28:31], s85 offen offset:3072 sc1
  buffer_load_dwordx4 v[220:223], v1, s[28:31], s84 offen offset:3072 sc1
  s_add_u32 s85, s85, 4096
  s_add_u32 s84, s84, 4096
  s_waitcnt lgkmcnt(12)
  v_mfma_f32_16x16x32_bf16 v[88:91], v[52:55], v[152:155], v[88:91]
  ds_read_b64_tr_b16 v[44:45], v13 offset:32832
  ds_read_b64_tr_b16 v[46:47], v13 offset:34624
  v_mfma_f32_16x16x32_bf16 v[92:95], v[52:55], v[156:159], v[92:95]
  s_waitcnt lgkmcnt(12)
  v_mfma_f32_16x16x32_bf16 v[96:99], v[56:59], v[152:155], v[96:99]
  ds_read_b64_tr_b16 v[48:49], v13 offset:32864
  ds_read_b64_tr_b16 v[50:51], v13 offset:34656
  v_mfma_f32_16x16x32_bf16 v[100:103], v[56:59], v[156:159], v[100:103]
  s_waitcnt lgkmcnt(12)
  v_mfma_f32_16x16x32_bf16 v[104:107], v[60:63], v[152:155], v[104:107]
  ds_read_b64_tr_b16 v[52:53], v13 offset:32896
  ds_read_b64_tr_b16 v[54:55], v13 offset:34688
  v_mfma_f32_16x16x32_bf16 v[108:111], v[60:63], v[156:159], v[108:111]
  s_waitcnt lgkmcnt(12)
  v_mfma_f32_16x16x32_bf16 v[112:115], v[64:67], v[152:155], v[112:115]
  ds_read_b64_tr_b16 v[56:57], v13 offset:32928
  ds_read_b64_tr_b16 v[58:59], v13 offset:34720
  v_mfma_f32_16x16x32_bf16 v[116:119], v[64:67], v[156:159], v[116:119]
  s_waitcnt lgkmcnt(12)
  v_mfma_f32_16x16x32_bf16 v[120:123], v[32:35], v[152:155], v[120:123]
  ds_read_b64_tr_b16 v[60:61], v13 offset:32960
  ds_read_b64_tr_b16 v[62:63], v13 offset:34752
  v_mfma_f32_16x16x32_bf16 v[124:127], v[32:35], v[156:159], v[124:127]
  s_waitcnt vmcnt(18) lgkmcnt(12)
  v_mfma_f32_16x16x32_bf16 v[72:75], v[36:39], v[160:163], v[72:75]
  ds_read_b64_tr_b16 v[64:65], v13 offset:39936
  ds_read_b64_tr_b16 v[66:67], v13 offset:41728
  v_mfma_f32_16x16x32_bf16 v[76:79], v[36:39], v[164:167], v[76:79]
  s_waitcnt lgkmcnt(12)
  v_mfma_f32_16x16x32_bf16 v[80:83], v[40:43], v[160:163], v[80:83]
  ds_read_b64_tr_b16 v[32:33], v13 offset:39968
  ds_read_b64_tr_b16 v[34:35], v13 offset:41760
  v_mfma_f32_16x16x32_bf16 v[84:87], v[40:43], v[164:167], v[84:87]
  buffer_load_dwordx4 v[224:227], v1, s[28:31], s85 offen offset:0 sc1
  buffer_load_dwordx4 v[228:231], v1, s[28:31], s84 offen offset:0 sc1
  buffer_load_dwordx4 v[232:235], v1, s[28:31], s85 offen offset:1024 sc1
  buffer_load_dwordx4 v[236:239], v1, s[28:31], s84 offen offset:1024 sc1
  s_waitcnt lgkmcnt(12)
  v_mfma_f32_16x16x32_bf16 v[88:91], v[44:47], v[160:163], v[88:91]
  ds_read_b64_tr_b16 v[36:37], v13 offset:40000
  ds_read_b64_tr_b16 v[38:39], v13 offset:41792
  v_mfma_f32_16x16x32_bf16 v[92:95], v[44:47], v[164:167], v[92:95]
  s_waitcnt lgkmcnt(12)
  v_mfma_f32_16x16x32_bf16 v[96:99], v[48:51], v[160:163], v[96:99]
  ds_read_b64_tr_b16 v[40:41], v13 offset:40032
  ds_read_b64_tr_b16 v[42:43], v13 offset:41824
  v_mfma_f32_16x16x32_bf16 v[100:103], v[48:51], v[164:167], v[100:103]
  s_waitcnt lgkmcnt(12)
  v_mfma_f32_16x16x32_bf16 v[104:107], v[52:55], v[160:163], v[104:107]
  ds_read_b64_tr_b16 v[44:45], v13 offset:40064
  ds_read_b64_tr_b16 v[46:47], v13 offset:41856
  v_mfma_f32_16x16x32_bf16 v[108:111], v[52:55], v[164:167], v[108:111]
  s_waitcnt lgkmcnt(12)
  v_mfma_f32_16x16x32_bf16 v[112:115], v[56:59], v[160:163], v[112:115]
  ds_read_b64_tr_b16 v[48:49], v13 offset:40096
  ds_read_b64_tr_b16 v[50:51], v13 offset:41888
  v_mfma_f32_16x16x32_bf16 v[116:119], v[56:59], v[164:167], v[116:119]
  s_waitcnt lgkmcnt(12)
  v_mfma_f32_16x16x32_bf16 v[120:123], v[60:63], v[160:163], v[120:123]
  ds_read_b64_tr_b16 v[52:53], v13 offset:40128
  ds_read_b64_tr_b16 v[54:55], v13 offset:41920
  v_mfma_f32_16x16x32_bf16 v[124:127], v[60:63], v[164:167], v[124:127]
  s_waitcnt vmcnt(20) lgkmcnt(12)
  v_mfma_f32_16x16x32_bf16 v[72:75], v[64:67], v[168:171], v[72:75]
  ds_read_b64_tr_b16 v[56:57], v13 offset:47104
  ds_read_b64_tr_b16 v[58:59], v13 offset:48896
  v_mfma_f32_16x16x32_bf16 v[76:79], v[64:67], v[172:175], v[76:79]
  s_waitcnt lgkmcnt(12)
  v_mfma_f32_16x16x32_bf16 v[80:83], v[32:35], v[168:171], v[80:83]
  ds_read_b64_tr_b16 v[60:61], v13 offset:47136
  ds_read_b64_tr_b16 v[62:63], v13 offset:48928
  v_mfma_f32_16x16x32_bf16 v[84:87], v[32:35], v[172:175], v[84:87]
  buffer_load_dwordx4 v[240:243], v1, s[28:31], s85 offen offset:2048 sc1
  buffer_load_dwordx4 v[244:247], v1, s[28:31], s84 offen offset:2048 sc1
  buffer_load_dwordx4 v[248:251], v1, s[28:31], s85 offen offset:3072 sc1
  buffer_load_dwordx4 v[252:255], v1, s[28:31], s84 offen offset:3072 sc1
  s_waitcnt lgkmcnt(12)
  v_mfma_f32_16x16x32_bf16 v[88:91], v[36:39], v[168:171], v[88:91]
  ds_read_b64_tr_b16 v[64:65], v13 offset:47168
  ds_read_b64_tr_b16 v[66:67], v13 offset:48960
  v_mfma_f32_16x16x32_bf16 v[92:95], v[36:39], v[172:175], v[92:95]
  s_waitcnt lgkmcnt(12)
  v_mfma_f32_16x16x32_bf16 v[96:99], v[40:43], v[168:171], v[96:99]
  ds_read_b64_tr_b16 v[32:33], v13 offset:47200
  ds_read_b64_tr_b16 v[34:35], v13 offset:48992
  v_mfma_f32_16x16x32_bf16 v[100:103], v[40:43], v[172:175], v[100:103]
  s_waitcnt lgkmcnt(12)
  v_mfma_f32_16x16x32_bf16 v[104:107], v[44:47], v[168:171], v[104:107]
  ds_read_b64_tr_b16 v[36:37], v13 offset:47232
  ds_read_b64_tr_b16 v[38:39], v13 offset:49024
  v_mfma_f32_16x16x32_bf16 v[108:111], v[44:47], v[172:175], v[108:111]
  s_waitcnt lgkmcnt(12)
  v_mfma_f32_16x16x32_bf16 v[112:115], v[48:51], v[168:171], v[112:115]
  ds_read_b64_tr_b16 v[40:41], v13 offset:47264
  ds_read_b64_tr_b16 v[42:43], v13 offset:49056
  v_mfma_f32_16x16x32_bf16 v[116:119], v[48:51], v[172:175], v[116:119]
  s_waitcnt lgkmcnt(12)
  v_mfma_f32_16x16x32_bf16 v[120:123], v[52:55], v[168:171], v[120:123]
  ds_read_b64_tr_b16 v[44:45], v13 offset:47296
  ds_read_b64_tr_b16 v[46:47], v13 offset:49088
  v_mfma_f32_16x16x32_bf16 v[124:127], v[52:55], v[172:175], v[124:127]
  s_waitcnt vmcnt(22) lgkmcnt(12)
  v_mfma_f32_16x16x32_bf16 v[72:75], v[56:59], v[176:179], v[72:75]
  ds_read_b64_tr_b16 v[48:49], v13 offset:54272
  ds_read_b64_tr_b16 v[50:51], v13 offset:56064
  v_mfma_f32_16x16x32_bf16 v[76:79], v[56:59], v[180:183], v[76:79]
  s_waitcnt lgkmcnt(12)
  v_mfma_f32_16x16x32_bf16 v[80:83], v[60:63], v[176:179], v[80:83]
  ds_read_b64_tr_b16 v[52:53], v13 offset:54304
  ds_read_b64_tr_b16 v[54:55], v13 offset:56096
  v_mfma_f32_16x16x32_bf16 v[84:87], v[60:63], v[180:183], v[84:87]
  s_waitcnt lgkmcnt(12)
  v_mfma_f32_16x16x32_bf16 v[88:91], v[64:67], v[176:179], v[88:91]
  ds_read_b64_tr_b16 v[56:57], v13 offset:54336
  ds_read_b64_tr_b16 v[58:59], v13 offset:56128
  v_mfma_f32_16x16x32_bf16 v[92:95], v[64:67], v[180:183], v[92:95]
  s_waitcnt lgkmcnt(12)
  v_mfma_f32_16x16x32_bf16 v[96:99], v[32:35], v[176:179], v[96:99]
  ds_read_b64_tr_b16 v[60:61], v13 offset:54368
  ds_read_b64_tr_b16 v[62:63], v13 offset:56160
  v_mfma_f32_16x16x32_bf16 v[100:103], v[32:35], v[180:183], v[100:103]
  s_waitcnt lgkmcnt(12)
  v_mfma_f32_16x16x32_bf16 v[104:107], v[36:39], v[176:179], v[104:107]
  ds_read_b64_tr_b16 v[64:65], v13 offset:54400
  ds_read_b64_tr_b16 v[66:67], v13 offset:56192
  v_mfma_f32_16x16x32_bf16 v[108:111], v[36:39], v[180:183], v[108:111]
  s_waitcnt lgkmcnt(12)
  v_mfma_f32_16x16x32_bf16 v[112:115], v[40:43], v[176:179], v[112:115]
  ds_read_b64_tr_b16 v[32:33], v13 offset:54432
  ds_read_b64_tr_b16 v[34:35], v13 offset:56224
  v_mfma_f32_16x16x32_bf16 v[116:119], v[40:43], v[180:183], v[116:119]
  s_waitcnt lgkmcnt(12)
  v_mfma_f32_16x16x32_bf16 v[120:123], v[44:47], v[176:179], v[120:123]
  ds_read_b64_tr_b16 v[36:37], v13 offset:54464
  ds_read_b64_tr_b16 v[38:39], v13 offset:56256
  v_mfma_f32_16x16x32_bf16 v[124:127], v[44:47], v[180:183], v[124:127]
  s_waitcnt vmcnt(20) lgkmcnt(12)
  v_mfma_f32_16x16x32_bf16 v[72:75], v[48:51], v[184:187], v[72:75]
  ds_read_b64_tr_b16 v[40:41], v13 offset:61440
  ds_read_b64_tr_b16 v[42:43], v13 offset:63232
  v_mfma_f32_16x16x32_bf16 v[76:79], v[48:51], v[188:191], v[76:79]
  s_waitcnt lgkmcnt(12)
  v_mfma_f32_16x16x32_bf16 v[80:83], v[52:55], v[184:187], v[80:83]
  ds_read_b64_tr_b16 v[44:45], v13 offset:61472
  ds_read_b64_tr_b16 v[46:47], v13 offset:63264
  v_mfma_f32_16x16x32_bf16 v[84:87], v[52:55], v[188:191], v[84:87]
  s_waitcnt lgkmcnt(12)
  v_mfma_f32_16x16x32_bf16 v[88:91], v[56:59], v[184:187], v[88:91]
  ds_read_b64_tr_b16 v[48:49], v13 offset:61504
  ds_read_b64_tr_b16 v[50:51], v13 offset:63296
  v_mfma_f32_16x16x32_bf16 v[92:95], v[56:59], v[188:191], v[92:95]
  s_waitcnt lgkmcnt(12)
  v_mfma_f32_16x16x32_bf16 v[96:99], v[60:63], v[184:187], v[96:99]
  ds_read_b64_tr_b16 v[52:53], v13 offset:61536
  ds_read_b64_tr_b16 v[54:55], v13 offset:63328
  v_mfma_f32_16x16x32_bf16 v[100:103], v[60:63], v[188:191], v[100:103]
  s_waitcnt lgkmcnt(12)
  v_mfma_f32_16x16x32_bf16 v[104:107], v[64:67], v[184:187], v[104:107]
  ds_read_b64_tr_b16 v[56:57], v13 offset:61568
  ds_read_b64_tr_b16 v[58:59], v13 offset:63360
  v_mfma_f32_16x16x32_bf16 v[108:111], v[64:67], v[188:191], v[108:111]
  s_waitcnt lgkmcnt(12)
  v_mfma_f32_16x16x32_bf16 v[112:115], v[32:35], v[184:187], v[112:115]
  ds_read_b64_tr_b16 v[60:61], v13 offset:61600
  ds_read_b64_tr_b16 v[62:63], v13 offset:63392
  v_mfma_f32_16x16x32_bf16 v[116:119], v[32:35], v[188:191], v[116:119]
  s_waitcnt lgkmcnt(12)
  v_mfma_f32_16x16x32_bf16 v[120:123], v[36:39], v[184:187], v[120:123]
  ds_read_b64_tr_b16 v[64:65], v13 offset:61632
  ds_read_b64_tr_b16 v[66:67], v13 offset:63424
  v_mfma_f32_16x16x32_bf16 v[124:127], v[36:39], v[188:191], v[124:127]
  s_waitcnt vmcnt(18) lgkmcnt(12)
  v_mfma_f32_16x16x32_bf16 v[72:75], v[40:43], v[192:195], v[72:75]
  ds_read_b64_tr_b16 v[32:33], v14 offset:3072
  ds_read_b64_tr_b16 v[34:35], v14 offset:4864
  v_mfma_f32_16x16x32_bf16 v[76:79], v[40:43], v[196:199], v[76:79]
  s_waitcnt lgkmcnt(12)
  v_mfma_f32_16x16x32_bf16 v[80:83], v[44:47], v[192:195], v[80:83]
  ds_read_b64_tr_b16 v[36:37], v14 offset:3104
  ds_read_b64_tr_b16 v[38:39], v14 offset:4896
  v_mfma_f32_16x16x32_bf16 v[84:87], v[44:47], v[196:199], v[84:87]
  s_waitcnt lgkmcnt(12)
  v_mfma_f32_16x16x32_bf16 v[88:91], v[48:51], v[192:195], v[88:91]
  ds_read_b64_tr_b16 v[40:41], v14 offset:3136
  ds_read_b64_tr_b16 v[42:43], v14 offset:4928
  v_mfma_f32_16x16x32_bf16 v[92:95], v[48:51], v[196:199], v[92:95]
  s_waitcnt lgkmcnt(12)
  v_mfma_f32_16x16x32_bf16 v[96:99], v[52:55], v[192:195], v[96:99]
  ds_read_b64_tr_b16 v[44:45], v14 offset:3168
  ds_read_b64_tr_b16 v[46:47], v14 offset:4960
  v_mfma_f32_16x16x32_bf16 v[100:103], v[52:55], v[196:199], v[100:103]
  s_waitcnt lgkmcnt(12)
  v_mfma_f32_16x16x32_bf16 v[104:107], v[56:59], v[192:195], v[104:107]
  ds_read_b64_tr_b16 v[48:49], v14 offset:3200
  ds_read_b64_tr_b16 v[50:51], v14 offset:4992
  v_mfma_f32_16x16x32_bf16 v[108:111], v[56:59], v[196:199], v[108:111]
  s_waitcnt lgkmcnt(12)
  v_mfma_f32_16x16x32_bf16 v[112:115], v[60:63], v[192:195], v[112:115]
  ds_read_b64_tr_b16 v[52:53], v14 offset:3232
  ds_read_b64_tr_b16 v[54:55], v14 offset:5024
  v_mfma_f32_16x16x32_bf16 v[116:119], v[60:63], v[196:199], v[116:119]
  s_waitcnt lgkmcnt(12)
  v_mfma_f32_16x16x32_bf16 v[120:123], v[64:67], v[192:195], v[120:123]
  ds_read_b64_tr_b16 v[56:57], v14 offset:3264
  ds_read_b64_tr_b16 v[58:59], v14 offset:5056
  v_mfma_f32_16x16x32_bf16 v[124:127], v[64:67], v[196:199], v[124:127]
  s_waitcnt vmcnt(16) lgkmcnt(12)
  s_waitcnt vmcnt(12)
  v_mfma_f32_16x16x32_bf16 v[72:75], v[32:35], v[200:203], v[72:75]
  ds_read_b64_tr_b16 v[60:61], v14 offset:10240
  ds_read_b64_tr_b16 v[62:63], v14 offset:12032
  v_mfma_f32_16x16x32_bf16 v[76:79], v[32:35], v[204:207], v[76:79]
  v_pk_add_f32 v[16:17], v[16:17], v[18:19]
  s_waitcnt lgkmcnt(12)
  v_mfma_f32_16x16x32_bf16 v[80:83], v[36:39], v[200:203], v[80:83]
  ds_read_b64_tr_b16 v[64:65], v14 offset:10272
  ds_read_b64_tr_b16 v[66:67], v14 offset:12064
  v_mfma_f32_16x16x32_bf16 v[84:87], v[36:39], v[204:207], v[84:87]
  v_pk_add_f32 v[20:21], v[20:21], v[22:23]
  s_waitcnt lgkmcnt(12)
  v_mfma_f32_16x16x32_bf16 v[88:91], v[40:43], v[200:203], v[88:91]
  ds_read_b64_tr_b16 v[32:33], v14 offset:10304
  ds_read_b64_tr_b16 v[34:35], v14 offset:12096
  v_mfma_f32_16x16x32_bf16 v[92:95], v[40:43], v[204:207], v[92:95]
  v_pk_add_f32 v[24:25], v[24:25], v[26:27]
  s_waitcnt lgkmcnt(12)
  v_mfma_f32_16x16x32_bf16 v[96:99], v[44:47], v[200:203], v[96:99]
  ds_read_b64_tr_b16 v[36:37], v14 offset:10336
  ds_read_b64_tr_b16 v[38:39], v14 offset:12128
  v_mfma_f32_16x16x32_bf16 v[100:103], v[44:47], v[204:207], v[100:103]
  v_pk_add_f32 v[28:29], v[28:29], v[30:31]
  s_waitcnt lgkmcnt(12)
  v_mfma_f32_16x16x32_bf16 v[104:107], v[48:51], v[200:203], v[104:107]
  ds_read_b64_tr_b16 v[40:41], v14 offset:10368
  ds_read_b64_tr_b16 v[42:43], v14 offset:12160
  v_mfma_f32_16x16x32_bf16 v[108:111], v[48:51], v[204:207], v[108:111]
  v_pk_add_f32 v[16:17], v[16:17], v[20:21]
  s_waitcnt lgkmcnt(12)
  v_mfma_f32_16x16x32_bf16 v[112:115], v[52:55], v[200:203], v[112:115]
  ds_read_b64_tr_b16 v[44:45], v14 offset:10400
  ds_read_b64_tr_b16 v[46:47], v14 offset:12192
  v_mfma_f32_16x16x32_bf16 v[116:119], v[52:55], v[204:207], v[116:119]
  v_pk_add_f32 v[24:25], v[24:25], v[28:29]
  s_waitcnt lgkmcnt(12)
  v_mfma_f32_16x16x32_bf16 v[120:123], v[56:59], v[200:203], v[120:123]
  ds_read_b64_tr_b16 v[48:49], v14 offset:10432
  ds_read_b64_tr_b16 v[50:51], v14 offset:12224
  v_mfma_f32_16x16x32_bf16 v[124:127], v[56:59], v[204:207], v[124:127]
  v_pk_add_f32 v[16:17], v[16:17], v[24:25]
  s_barrier
  s_waitcnt vmcnt(10) lgkmcnt(12)
  v_mfma_f32_16x16x32_bf16 v[72:75], v[60:63], v[208:211], v[72:75]
  ds_read_b64_tr_b16 v[52:53], v14 offset:17408
  ds_read_b64_tr_b16 v[54:55], v14 offset:19200
  v_mfma_f32_16x16x32_bf16 v[76:79], v[60:63], v[212:215], v[76:79]
  v_mov_b32 v20, v16
  s_waitcnt lgkmcnt(12)
  v_mfma_f32_16x16x32_bf16 v[80:83], v[64:67], v[208:211], v[80:83]
  ds_read_b64_tr_b16 v[56:57], v14 offset:17440
  ds_read_b64_tr_b16 v[58:59], v14 offset:19232
  v_mfma_f32_16x16x32_bf16 v[84:87], v[64:67], v[212:215], v[84:87]
  v_mov_b32 v21, v17
  s_waitcnt lgkmcnt(12)
  v_mfma_f32_16x16x32_bf16 v[88:91], v[32:35], v[208:211], v[88:91]
  ds_read_b64_tr_b16 v[60:61], v14 offset:17472
  ds_read_b64_tr_b16 v[62:63], v14 offset:19264
  v_mfma_f32_16x16x32_bf16 v[92:95], v[32:35], v[212:215], v[92:95]
  v_permlane32_swap_b32 v16, v20
  s_waitcnt lgkmcnt(12)
  v_mfma_f32_16x16x32_bf16 v[96:99], v[36:39], v[208:211], v[96:99]
  ds_read_b64_tr_b16 v[64:65], v14 offset:17504
  ds_read_b64_tr_b16 v[66:67], v14 offset:19296
  v_mfma_f32_16x16x32_bf16 v[100:103], v[36:39], v[212:215], v[100:103]
  v_permlane32_swap_b32 v17, v21
  s_waitcnt lgkmcnt(12)
  v_mfma_f32_16x16x32_bf16 v[104:107], v[40:43], v[208:211], v[104:107]
  ds_read_b64_tr_b16 v[32:33], v14 offset:17536
  ds_read_b64_tr_b16 v[34:35], v14 offset:19328
  v_mfma_f32_16x16x32_bf16 v[108:111], v[40:43], v[212:215], v[108:111]
  v_add_f32 v16, v16, v20
  s_waitcnt lgkmcnt(12)
  v_mfma_f32_16x16x32_bf16 v[112:115], v[44:47], v[208:211], v[112:115]
  ds_read_b64_tr_b16 v[36:37], v14 offset:17568
  ds_read_b64_tr_b16 v[38:39], v14 offset:19360
  v_mfma_f32_16x16x32_bf16 v[116:119], v[44:47], v[212:215], v[116:119]
  v_add_f32 v17, v17, v21
  s_waitcnt lgkmcnt(12)
  v_mfma_f32_16x16x32_bf16 v[120:123], v[48:51], v[208:211], v[120:123]
  ds_read_b64_tr_b16 v[40:41], v14 offset:17600
  ds_read_b64_tr_b16 v[42:43], v14 offset:19392
  v_mfma_f32_16x16x32_bf16 v[124:127], v[48:51], v[212:215], v[124:127]
  v_mul_f32 v16, 0x3b000000, v16
  s_waitcnt vmcnt(8) lgkmcnt(12)
  v_mfma_f32_16x16x32_bf16 v[72:75], v[52:55], v[216:219], v[72:75]
  ds_read_b64_tr_b16 v[44:45], v12 offset:0
  ds_read_b64_tr_b16 v[46:47], v12 offset:1792
  v_mfma_f32_16x16x32_bf16 v[76:79], v[52:55], v[220:223], v[76:79]
  v_mul_f32 v17, 0x3b000000, v17
  s_waitcnt lgkmcnt(12)
  v_mfma_f32_16x16x32_bf16 v[80:83], v[56:59], v[216:219], v[80:83]
  ds_read_b64_tr_b16 v[48:49], v12 offset:32
  ds_read_b64_tr_b16 v[50:51], v12 offset:1824
  v_mfma_f32_16x16x32_bf16 v[84:87], v[56:59], v[220:223], v[84:87]
  v_fma_f32 v17, -v16, v16, v17
  s_waitcnt lgkmcnt(12)
  v_mfma_f32_16x16x32_bf16 v[88:91], v[60:63], v[216:219], v[88:91]
  ds_read_b64_tr_b16 v[52:53], v12 offset:64
  ds_read_b64_tr_b16 v[54:55], v12 offset:1856
  v_mfma_f32_16x16x32_bf16 v[92:95], v[60:63], v[220:223], v[92:95]
  v_max_f32 v17, 0, v17
  s_waitcnt lgkmcnt(12)
  v_mfma_f32_16x16x32_bf16 v[96:99], v[64:67], v[216:219], v[96:99]
  ds_read_b64_tr_b16 v[56:57], v12 offset:96
  ds_read_b64_tr_b16 v[58:59], v12 offset:1888
  v_mfma_f32_16x16x32_bf16 v[100:103], v[64:67], v[220:223], v[100:103]
  v_cvt_pk_bf16_f32 v24, v16, v16
  s_waitcnt lgkmcnt(12)
  v_mfma_f32_16x16x32_bf16 v[104:107], v[32:35], v[216:219], v[104:107]
  ds_read_b64_tr_b16 v[60:61], v12 offset:128
  ds_read_b64_tr_b16 v[62:63], v12 offset:1920
  v_mfma_f32_16x16x32_bf16 v[108:111], v[32:35], v[220:223], v[108:111]
  v_cvt_pk_bf16_f32 v20, v17, v17
  s_waitcnt lgkmcnt(12)
  v_mfma_f32_16x16x32_bf16 v[112:115], v[36:39], v[216:219], v[112:115]
  ds_read_b64_tr_b16 v[64:65], v12 offset:160
  ds_read_b64_tr_b16 v[66:67], v12 offset:1952
  v_mfma_f32_16x16x32_bf16 v[116:119], v[36:39], v[220:223], v[116:119]
  v_lshlrev_b32 v20, 16, v20
  s_waitcnt lgkmcnt(12)
  v_mfma_f32_16x16x32_bf16 v[120:123], v[40:43], v[216:219], v[120:123]
  ds_read_b64_tr_b16 v[32:33], v12 offset:192
  ds_read_b64_tr_b16 v[34:35], v12 offset:1984
  v_mfma_f32_16x16x32_bf16 v[124:127], v[40:43], v[220:223], v[124:127]
  v_add_f32 v20, 0x3727c5ac, v20
  s_waitcnt vmcnt(6) lgkmcnt(12)
  v_mfma_f32_16x16x32_bf16 v[72:75], v[44:47], v[224:227], v[72:75]
  ds_read_b64_tr_b16 v[36:37], v12 offset:7168
  ds_read_b64_tr_b16 v[38:39], v12 offset:8960
  v_mfma_f32_16x16x32_bf16 v[76:79], v[44:47], v[228:231], v[76:79]
  v_cvt_pk_bf16_f32 v20, v20, v20
  s_waitcnt lgkmcnt(12)
  v_mfma_f32_16x16x32_bf16 v[80:83], v[48:51], v[224:227], v[80:83]
  ds_read_b64_tr_b16 v[40:41], v12 offset:7200
  ds_read_b64_tr_b16 v[42:43], v12 offset:8992
  v_mfma_f32_16x16x32_bf16 v[84:87], v[48:51], v[228:231], v[84:87]
  v_lshlrev_b32 v20, 16, v20
  s_waitcnt lgkmcnt(12)
  v_mfma_f32_16x16x32_bf16 v[88:91], v[52:55], v[224:227], v[88:91]
  ds_read_b64_tr_b16 v[44:45], v12 offset:7232
  ds_read_b64_tr_b16 v[46:47], v12 offset:9024
  v_mfma_f32_16x16x32_bf16 v[92:95], v[52:55], v[228:231], v[92:95]
  v_sqrt_f32 v20, v20
  s_waitcnt lgkmcnt(12)
  v_mfma_f32_16x16x32_bf16 v[96:99], v[56:59], v[224:227], v[96:99]
  ds_read_b64_tr_b16 v[48:49], v12 offset:7264
  ds_read_b64_tr_b16 v[50:51], v12 offset:9056
  v_mfma_f32_16x16x32_bf16 v[100:103], v[56:59], v[228:231], v[100:103]
  v_cvt_pk_bf16_f32 v25, v20, v20
  s_waitcnt lgkmcnt(12)
  v_mfma_f32_16x16x32_bf16 v[104:107], v[60:63], v[224:227], v[104:107]
  ds_read_b64_tr_b16 v[52:53], v12 offset:7296
  ds_read_b64_tr_b16 v[54:55], v12 offset:9088
  v_mfma_f32_16x16x32_bf16 v[108:111], v[60:63], v[228:231], v[108:111]
  v_lshlrev_b32 v20, 16, v25
  s_waitcnt lgkmcnt(12)
  v_mfma_f32_16x16x32_bf16 v[112:115], v[64:67], v[224:227], v[112:115]
  ds_read_b64_tr_b16 v[56:57], v12 offset:7328
  ds_read_b64_tr_b16 v[58:59], v12 offset:9120
  v_mfma_f32_16x16x32_bf16 v[116:119], v[64:67], v[228:231], v[116:119]
  v_rcp_f32 v26, v20
  s_waitcnt lgkmcnt(12)
  v_mfma_f32_16x16x32_bf16 v[120:123], v[32:35], v[224:227], v[120:123]
  ds_read_b64_tr_b16 v[60:61], v12 offset:7360
  ds_read_b64_tr_b16 v[62:63], v12 offset:9152
  v_mfma_f32_16x16x32_bf16 v[124:127], v[32:35], v[228:231], v[124:127]
  v_and_b32 v25, 0xffff, v25
  s_waitcnt vmcnt(4) lgkmcnt(12)
  v_mfma_f32_16x16x32_bf16 v[72:75], v[36:39], v[232:235], v[72:75]
  ds_read_b64_tr_b16 v[64:65], v12 offset:14336
  ds_read_b64_tr_b16 v[66:67], v12 offset:16128
  v_mfma_f32_16x16x32_bf16 v[76:79], v[36:39], v[236:239], v[76:79]
  v_mov_b32 v20, v24
  s_waitcnt lgkmcnt(12)
  v_mfma_f32_16x16x32_bf16 v[80:83], v[40:43], v[232:235], v[80:83]
  ds_read_b64_tr_b16 v[32:33], v12 offset:14368
  ds_read_b64_tr_b16 v[34:35], v12 offset:16160
  v_mfma_f32_16x16x32_bf16 v[84:87], v[40:43], v[236:239], v[84:87]
  v_mov_b32 v68, v24
  s_waitcnt lgkmcnt(12)
  v_mfma_f32_16x16x32_bf16 v[88:91], v[44:47], v[232:235], v[88:91]
  ds_read_b64_tr_b16 v[36:37], v12 offset:14400
  ds_read_b64_tr_b16 v[38:39], v12 offset:16192
  v_mfma_f32_16x16x32_bf16 v[92:95], v[44:47], v[236:239], v[92:95]
  v_mov_b32 v21, v25
  s_waitcnt lgkmcnt(12)
  v_mfma_f32_16x16x32_bf16 v[96:99], v[48:51], v[232:235], v[96:99]
  ds_read_b64_tr_b16 v[40:41], v12 offset:14432
  ds_read_b64_tr_b16 v[42:43], v12 offset:16224
  v_mfma_f32_16x16x32_bf16 v[100:103], v[48:51], v[236:239], v[100:103]
  v_mov_b32 v69, v25
  s_waitcnt lgkmcnt(12)
  v_mfma_f32_16x16x32_bf16 v[104:107], v[52:55], v[232:235], v[104:107]
  ds_read_b64_tr_b16 v[44:45], v12 offset:14464
  ds_read_b64_tr_b16 v[46:47], v12 offset:16256
  v_mfma_f32_16x16x32_bf16 v[108:111], v[52:55], v[236:239], v[108:111]
  v_mov_b32 v28, v26
  s_waitcnt lgkmcnt(12)
  v_mfma_f32_16x16x32_bf16 v[112:115], v[56:59], v[232:235], v[112:115]
  ds_read_b64_tr_b16 v[48:49], v12 offset:14496
  ds_read_b64_tr_b16 v[50:51], v12 offset:16288
  v_mfma_f32_16x16x32_bf16 v[116:119], v[56:59], v[236:239], v[116:119]
  v_mov_b32 v30, v26
  s_waitcnt lgkmcnt(12)
  v_mfma_f32_16x16x32_bf16 v[120:123], v[60:63], v[232:235], v[120:123]
  ds_read_b64_tr_b16 v[52:53], v12 offset:14528
  ds_read_b64_tr_b16 v[54:55], v12 offset:16320
  v_mfma_f32_16x16x32_bf16 v[124:127], v[60:63], v[236:239], v[124:127]
  v_permlane16_swap_b32 v20, v68
  s_waitcnt vmcnt(2) lgkmcnt(12)
  v_mfma_f32_16x16x32_bf16 v[72:75], v[64:67], v[240:243], v[72:75]
  ds_read_b64_tr_b16 v[56:57], v12 offset:21504
  ds_read_b64_tr_b16 v[58:59], v12 offset:23296
  v_mfma_f32_16x16x32_bf16 v[76:79], v[64:67], v[244:247], v[76:79]
  v_permlane16_swap_b32 v21, v69
  s_waitcnt lgkmcnt(12)
  v_mfma_f32_16x16x32_bf16 v[80:83], v[32:35], v[240:243], v[80:83]
  ds_read_b64_tr_b16 v[60:61], v12 offset:21536
  ds_read_b64_tr_b16 v[62:63], v12 offset:23328
  v_mfma_f32_16x16x32_bf16 v[84:87], v[32:35], v[244:247], v[84:87]
  v_permlane16_swap_b32 v28, v30
  s_waitcnt lgkmcnt(12)
  v_mfma_f32_16x16x32_bf16 v[88:91], v[36:39], v[240:243], v[88:91]
  ds_read_b64_tr_b16 v[64:65], v12 offset:21568
  ds_read_b64_tr_b16 v[66:67], v12 offset:23360
  v_mfma_f32_16x16x32_bf16 v[92:95], v[36:39], v[244:247], v[92:95]
  v_cmp_gt_u32 vcc, 16, v0
  s_waitcnt lgkmcnt(12)
  v_mfma_f32_16x16x32_bf16 v[96:99], v[40:43], v[240:243], v[96:99]
  ds_read_b64_tr_b16 v[32:33], v12 offset:21600
  ds_read_b64_tr_b16 v[34:35], v12 offset:23392
  v_mfma_f32_16x16x32_bf16 v[100:103], v[40:43], v[244:247], v[100:103]
  v_cndmask_b32 v20, 0, v20, vcc
  s_waitcnt lgkmcnt(12)
  v_mfma_f32_16x16x32_bf16 v[104:107], v[44:47], v[240:243], v[104:107]
  ds_read_b64_tr_b16 v[36:37], v12 offset:21632
  ds_read_b64_tr_b16 v[38:39], v12 offset:23424
  v_mfma_f32_16x16x32_bf16 v[108:111], v[44:47], v[244:247], v[108:111]
  v_cndmask_b32 v21, 0, v21, vcc
  s_waitcnt lgkmcnt(12)
  v_mfma_f32_16x16x32_bf16 v[112:115], v[48:51], v[240:243], v[112:115]
  ds_read_b64_tr_b16 v[40:41], v12 offset:21664
  ds_read_b64_tr_b16 v[42:43], v12 offset:23456
  v_mfma_f32_16x16x32_bf16 v[116:119], v[48:51], v[244:247], v[116:119]
  v_mov_b32 v22, 0
  s_waitcnt lgkmcnt(12)
  v_mfma_f32_16x16x32_bf16 v[120:123], v[52:55], v[240:243], v[120:123]
  ds_read_b64_tr_b16 v[44:45], v12 offset:21696
  ds_read_b64_tr_b16 v[46:47], v12 offset:23488
  v_mfma_f32_16x16x32_bf16 v[124:127], v[52:55], v[244:247], v[124:127]
  v_mov_b32 v23, 0
  s_waitcnt vmcnt(0) lgkmcnt(12)
  v_mfma_f32_16x16x32_bf16 v[72:75], v[56:59], v[248:251], v[72:75]
  v_mfma_f32_16x16x32_bf16 v[76:79], v[56:59], v[252:255], v[76:79]
  v_cndmask_b32 v68, 0, v68, vcc
  s_waitcnt lgkmcnt(10)
  v_mfma_f32_16x16x32_bf16 v[80:83], v[60:63], v[248:251], v[80:83]
  v_mfma_f32_16x16x32_bf16 v[84:87], v[60:63], v[252:255], v[84:87]
  v_cndmask_b32 v69, 0, v69, vcc
  s_waitcnt lgkmcnt(8)
  v_mfma_f32_16x16x32_bf16 v[88:91], v[64:67], v[248:251], v[88:91]
  v_mfma_f32_16x16x32_bf16 v[92:95], v[64:67], v[252:255], v[92:95]
  v_mov_b32 v70, 0
  s_waitcnt lgkmcnt(6)
  v_mfma_f32_16x16x32_bf16 v[96:99], v[32:35], v[248:251], v[96:99]
  v_mfma_f32_16x16x32_bf16 v[100:103], v[32:35], v[252:255], v[100:103]
  v_mov_b32 v71, 0
  s_waitcnt lgkmcnt(4)
  v_mfma_f32_16x16x32_bf16 v[104:107], v[36:39], v[248:251], v[104:107]
  v_mfma_f32_16x16x32_bf16 v[108:111], v[36:39], v[252:255], v[108:111]
  s_waitcnt lgkmcnt(2)
  v_mfma_f32_16x16x32_bf16 v[112:115], v[40:43], v[248:251], v[112:115]
  v_mfma_f32_16x16x32_bf16 v[116:119], v[40:43], v[252:255], v[116:119]
  s_waitcnt lgkmcnt(0)
  v_mfma_f32_16x16x32_bf16 v[120:123], v[44:47], v[248:251], v[120:123]
  v_mfma_f32_16x16x32_bf16 v[124:127], v[44:47], v[252:255], v[124:127]
  v_and_b32 v60, 15, v0
  v_lshlrev_b32 v60, 3, v60
  v_add_u32 v60, 160768, v60
  ds_read_b64 v[32:33], v60 offset:0
  v_mov_b32 v34, 0
  v_mov_b32 v35, 0
  ds_read_b64 v[36:37], v60 offset:128
  v_mov_b32 v38, 0
  v_mov_b32 v39, 0
  ds_read_b64 v[40:41], v60 offset:256
  v_mov_b32 v42, 0
  v_mov_b32 v43, 0
  ds_read_b64 v[44:45], v60 offset:384
  v_mov_b32 v46, 0
  v_mov_b32 v47, 0
  ds_read_b64 v[48:49], v60 offset:512
  v_mov_b32 v50, 0
  v_mov_b32 v51, 0
  ds_read_b64 v[52:53], v60 offset:640
  v_mov_b32 v54, 0
  v_mov_b32 v55, 0
  ds_read_b64 v[56:57], v60 offset:768
  v_mov_b32 v58, 0
  v_mov_b32 v59, 0
  s_waitcnt lgkmcnt(6)
  v_mfma_f32_16x16x32_bf16 v[72:75], v[32:35], v[20:23], v[72:75]
  v_mfma_f32_16x16x32_bf16 v[76:79], v[32:35], v[68:71], v[76:79]
  s_waitcnt lgkmcnt(5)
  v_mfma_f32_16x16x32_bf16 v[80:83], v[36:39], v[20:23], v[80:83]
  v_mfma_f32_16x16x32_bf16 v[84:87], v[36:39], v[68:71], v[84:87]
  s_waitcnt lgkmcnt(4)
  v_mfma_f32_16x16x32_bf16 v[88:91], v[40:43], v[20:23], v[88:91]
  v_mfma_f32_16x16x32_bf16 v[92:95], v[40:43], v[68:71], v[92:95]
  s_waitcnt lgkmcnt(3)
  v_mfma_f32_16x16x32_bf16 v[96:99], v[44:47], v[20:23], v[96:99]
  v_mfma_f32_16x16x32_bf16 v[100:103], v[44:47], v[68:71], v[100:103]
  s_waitcnt lgkmcnt(2)
  v_mfma_f32_16x16x32_bf16 v[104:107], v[48:51], v[20:23], v[104:107]
  v_mfma_f32_16x16x32_bf16 v[108:111], v[48:51], v[68:71], v[108:111]
  s_waitcnt lgkmcnt(1)
  v_mfma_f32_16x16x32_bf16 v[112:115], v[52:55], v[20:23], v[112:115]
  v_mfma_f32_16x16x32_bf16 v[116:119], v[52:55], v[68:71], v[116:119]
  s_waitcnt lgkmcnt(0)
  v_mfma_f32_16x16x32_bf16 v[120:123], v[56:59], v[20:23], v[120:123]
  v_mfma_f32_16x16x32_bf16 v[124:127], v[56:59], v[68:71], v[124:127]
  v_max_f32 v72, 0, v72
  v_max_f32 v73, 0, v73
  v_max_f32 v74, 0, v74
  v_max_f32 v75, 0, v75
  v_pk_mul_f32 v[72:73], v[72:73], v[28:29] op_sel_hi:[1,0]
  v_pk_mul_f32 v[74:75], v[74:75], v[28:29] op_sel_hi:[1,0]
  v_pk_mul_f32 v[72:73], v[72:73], v[72:73]
  v_pk_mul_f32 v[74:75], v[74:75], v[74:75]
  v_cvt_pk_bf16_f32 v128, v72, v73
  v_cvt_pk_bf16_f32 v129, v74, v75
  v_max_f32 v76, 0, v76
  v_max_f32 v77, 0, v77
  v_max_f32 v78, 0, v78
  v_max_f32 v79, 0, v79
  v_pk_mul_f32 v[76:77], v[76:77], v[30:31] op_sel_hi:[1,0]
  v_pk_mul_f32 v[78:79], v[78:79], v[30:31] op_sel_hi:[1,0]
  v_pk_mul_f32 v[76:77], v[76:77], v[76:77]
  v_pk_mul_f32 v[78:79], v[78:79], v[78:79]
  v_cvt_pk_bf16_f32 v130, v76, v77
  v_cvt_pk_bf16_f32 v131, v78, v79
  s_nop 0
  v_permlane32_swap_b32 v128, v130
  v_permlane32_swap_b32 v129, v131
  v_max_f32 v80, 0, v80
  v_max_f32 v81, 0, v81
  v_max_f32 v82, 0, v82
  v_max_f32 v83, 0, v83
  v_pk_mul_f32 v[80:81], v[80:81], v[28:29] op_sel_hi:[1,0]
  v_pk_mul_f32 v[82:83], v[82:83], v[28:29] op_sel_hi:[1,0]
  v_pk_mul_f32 v[80:81], v[80:81], v[80:81]
  v_pk_mul_f32 v[82:83], v[82:83], v[82:83]
  v_cvt_pk_bf16_f32 v132, v80, v81
  v_cvt_pk_bf16_f32 v133, v82, v83
  v_max_f32 v84, 0, v84
  v_max_f32 v85, 0, v85
  v_max_f32 v86, 0, v86
  v_max_f32 v87, 0, v87
  v_pk_mul_f32 v[84:85], v[84:85], v[30:31] op_sel_hi:[1,0]
  v_pk_mul_f32 v[86:87], v[86:87], v[30:31] op_sel_hi:[1,0]
  v_pk_mul_f32 v[84:85], v[84:85], v[84:85]
  v_pk_mul_f32 v[86:87], v[86:87], v[86:87]
  v_cvt_pk_bf16_f32 v134, v84, v85
  v_cvt_pk_bf16_f32 v135, v86, v87
  s_nop 0
  v_permlane32_swap_b32 v132, v134
  v_permlane32_swap_b32 v133, v135
  v_max_f32 v88, 0, v88
  v_max_f32 v89, 0, v89
  v_max_f32 v90, 0, v90
  v_max_f32 v91, 0, v91
  v_pk_mul_f32 v[88:89], v[88:89], v[28:29] op_sel_hi:[1,0]
  v_pk_mul_f32 v[90:91], v[90:91], v[28:29] op_sel_hi:[1,0]
  v_pk_mul_f32 v[88:89], v[88:89], v[88:89]
  v_pk_mul_f32 v[90:91], v[90:91], v[90:91]
  v_cvt_pk_bf16_f32 v136, v88, v89
  v_cvt_pk_bf16_f32 v137, v90, v91
  v_max_f32 v92, 0, v92
  v_max_f32 v93, 0, v93
  v_max_f32 v94, 0, v94
  v_max_f32 v95, 0, v95
  v_pk_mul_f32 v[92:93], v[92:93], v[30:31] op_sel_hi:[1,0]
  v_pk_mul_f32 v[94:95], v[94:95], v[30:31] op_sel_hi:[1,0]
  v_pk_mul_f32 v[92:93], v[92:93], v[92:93]
  v_pk_mul_f32 v[94:95], v[94:95], v[94:95]
  v_cvt_pk_bf16_f32 v138, v92, v93
  v_cvt_pk_bf16_f32 v139, v94, v95
  s_nop 0
  v_permlane32_swap_b32 v136, v138
  v_permlane32_swap_b32 v137, v139
  v_max_f32 v96, 0, v96
  v_max_f32 v97, 0, v97
  v_max_f32 v98, 0, v98
  v_max_f32 v99, 0, v99
  v_pk_mul_f32 v[96:97], v[96:97], v[28:29] op_sel_hi:[1,0]
  v_pk_mul_f32 v[98:99], v[98:99], v[28:29] op_sel_hi:[1,0]
  v_pk_mul_f32 v[96:97], v[96:97], v[96:97]
  v_pk_mul_f32 v[98:99], v[98:99], v[98:99]
  v_cvt_pk_bf16_f32 v140, v96, v97
  v_cvt_pk_bf16_f32 v141, v98, v99
  v_max_f32 v100, 0, v100
  v_max_f32 v101, 0, v101
  v_max_f32 v102, 0, v102
  v_max_f32 v103, 0, v103
  v_pk_mul_f32 v[100:101], v[100:101], v[30:31] op_sel_hi:[1,0]
  v_pk_mul_f32 v[102:103], v[102:103], v[30:31] op_sel_hi:[1,0]
  v_pk_mul_f32 v[100:101], v[100:101], v[100:101]
  v_pk_mul_f32 v[102:103], v[102:103], v[102:103]
  v_cvt_pk_bf16_f32 v142, v100, v101
  v_cvt_pk_bf16_f32 v143, v102, v103
  s_nop 0
  v_permlane32_swap_b32 v140, v142
  v_permlane32_swap_b32 v141, v143
  v_max_f32 v104, 0, v104
  v_max_f32 v105, 0, v105
  v_max_f32 v106, 0, v106
  v_max_f32 v107, 0, v107
  v_pk_mul_f32 v[104:105], v[104:105], v[28:29] op_sel_hi:[1,0]
  v_pk_mul_f32 v[106:107], v[106:107], v[28:29] op_sel_hi:[1,0]
  v_pk_mul_f32 v[104:105], v[104:105], v[104:105]
  v_pk_mul_f32 v[106:107], v[106:107], v[106:107]
  v_cvt_pk_bf16_f32 v144, v104, v105
  v_cvt_pk_bf16_f32 v145, v106, v107
  v_max_f32 v108, 0, v108
  v_max_f32 v109, 0, v109
  v_max_f32 v110, 0, v110
  v_max_f32 v111, 0, v111
  v_pk_mul_f32 v[108:109], v[108:109], v[30:31] op_sel_hi:[1,0]
  v_pk_mul_f32 v[110:111], v[110:111], v[30:31] op_sel_hi:[1,0]
  v_pk_mul_f32 v[108:109], v[108:109], v[108:109]
  v_pk_mul_f32 v[110:111], v[110:111], v[110:111]
  v_cvt_pk_bf16_f32 v146, v108, v109
  v_cvt_pk_bf16_f32 v147, v110, v111
  s_nop 0
  v_permlane32_swap_b32 v144, v146
  v_permlane32_swap_b32 v145, v147
  v_max_f32 v112, 0, v112
  v_max_f32 v113, 0, v113
  v_max_f32 v114, 0, v114
  v_max_f32 v115, 0, v115
  v_pk_mul_f32 v[112:113], v[112:113], v[28:29] op_sel_hi:[1,0]
  v_pk_mul_f32 v[114:115], v[114:115], v[28:29] op_sel_hi:[1,0]
  v_pk_mul_f32 v[112:113], v[112:113], v[112:113]
  v_pk_mul_f32 v[114:115], v[114:115], v[114:115]
  v_cvt_pk_bf16_f32 v148, v112, v113
  v_cvt_pk_bf16_f32 v149, v114, v115
  v_max_f32 v116, 0, v116
  v_max_f32 v117, 0, v117
  v_max_f32 v118, 0, v118
  v_max_f32 v119, 0, v119
  v_pk_mul_f32 v[116:117], v[116:117], v[30:31] op_sel_hi:[1,0]
  v_pk_mul_f32 v[118:119], v[118:119], v[30:31] op_sel_hi:[1,0]
  v_pk_mul_f32 v[116:117], v[116:117], v[116:117]
  v_pk_mul_f32 v[118:119], v[118:119], v[118:119]
  v_cvt_pk_bf16_f32 v150, v116, v117
  v_cvt_pk_bf16_f32 v151, v118, v119
  s_nop 0
  v_permlane32_swap_b32 v148, v150
  v_permlane32_swap_b32 v149, v151
  v_max_f32 v120, 0, v120
  v_max_f32 v121, 0, v121
  v_max_f32 v122, 0, v122
  v_max_f32 v123, 0, v123
  v_pk_mul_f32 v[120:121], v[120:121], v[28:29] op_sel_hi:[1,0]
  v_pk_mul_f32 v[122:123], v[122:123], v[28:29] op_sel_hi:[1,0]
  v_pk_mul_f32 v[120:121], v[120:121], v[120:121]
  v_pk_mul_f32 v[122:123], v[122:123], v[122:123]
  v_cvt_pk_bf16_f32 v152, v120, v121
  v_cvt_pk_bf16_f32 v153, v122, v123
  v_max_f32 v124, 0, v124
  v_max_f32 v125, 0, v125
  v_max_f32 v126, 0, v126
  v_max_f32 v127, 0, v127
  v_pk_mul_f32 v[124:125], v[124:125], v[30:31] op_sel_hi:[1,0]
  v_pk_mul_f32 v[126:127], v[126:127], v[30:31] op_sel_hi:[1,0]
  v_pk_mul_f32 v[124:125], v[124:125], v[124:125]
  v_pk_mul_f32 v[126:127], v[126:127], v[126:127]
  v_cvt_pk_bf16_f32 v154, v124, v125
  v_cvt_pk_bf16_f32 v155, v126, v127
  s_nop 0
  v_permlane32_swap_b32 v152, v154
  v_permlane32_swap_b32 v153, v155
  s_cmp_eq_u32 s7, 0
  s_cbranch_scc1 SLOW_52
  buffer_store_dwordx4 v[128:131], v15, s[28:31], s88 offen offset:0
  buffer_store_dwordx4 v[132:135], v15, s[28:31], s88 offen offset:1024
  buffer_store_dwordx4 v[136:139], v15, s[28:31], s88 offen offset:2048
  buffer_store_dwordx4 v[140:143], v15, s[28:31], s88 offen offset:3072
  buffer_store_dwordx4 v[144:147], v15, s[28:31], s89 offen offset:0
  buffer_store_dwordx4 v[148:151], v15, s[28:31], s89 offen offset:1024
  buffer_store_dwordx4 v[152:155], v15, s[28:31], s89 offen offset:2048
  s_branch SDONE_53
SLOW_52:
  buffer_store_dwordx4 v[128:131], v15, s[28:31], s88 offen offset:0 sc1
  buffer_store_dwordx4 v[132:135], v15, s[28:31], s88 offen offset:1024 sc1
  buffer_store_dwordx4 v[136:139], v15, s[28:31], s88 offen offset:2048 sc1
  buffer_store_dwordx4 v[140:143], v15, s[28:31], s88 offen offset:3072 sc1
  buffer_store_dwordx4 v[144:147], v15, s[28:31], s89 offen offset:0 sc1
  buffer_store_dwordx4 v[148:151], v15, s[28:31], s89 offen offset:1024 sc1
  buffer_store_dwordx4 v[152:155], v15, s[28:31], s89 offen offset:2048 sc1
SDONE_53:
  s_barrier
  s_waitcnt vmcnt(0)
  v_mov_b32 v18, s46
  s_mov_b64 exec, 1
  s_cmp_eq_u32 s7, 0
  s_cbranch_scc1 SLOW_54
  buffer_store_dword v18, off, s[28:31], s90
  s_branch SDONE_55
SLOW_54:
  buffer_store_dword v18, off, s[28:31], s90 sc1
SDONE_55:
  s_mov_b64 exec, -1
  v_lshrrev_b32 v16, 5, v0
  v_lshlrev_b32 v16, 2, v16
  v_and_b32 v17, 15, v0
  v_lshrrev_b32 v17, 2, v17
  v_add_u32 v16, v16, v17
  v_lshlrev_b32 v16, 7, v16
  v_lshrrev_b32 v17, 1, v17
  s_lshr_b32 s80, s6, 1
  v_xor_b32 v17, s80, v17
  v_and_b32 v17, 1, v17
  v_lshlrev_b32 v17, 6, v17
  v_add_u32 v16, v16, v17
  v_lshrrev_b32 v17, 4, v0
  v_and_b32 v17, 1, v17
  v_lshlrev_b32 v17, 5, v17
  v_add_u32 v16, v16, v17
  v_and_b32 v17, 3, v0
  v_lshlrev_b32 v17, 3, v17
  v_add_u32 v16, v16, v17
  s_lshl_b32 s80, s80, 11
  v_add_u32 v12, s80, v16
  v_xor_b32 v13, 64, v12
  v_add_u32 v14, 65536, v12
  v_add_u32 v15, 65536, v13
  v_add_u32 v22, 131072, v12
  v_add_u32 v23, 131072, v13
  s_lshr_b32 s87, s5, 3
  s_lshl_b32 s87, s87, 1
  s_and_b32 s86, s6, 1
  s_add_u32 s87, s87, s86
  s_lshl_b32 s86, s4, 2
  s_add_u32 s86, s86, s87
  s_and_b32 s80, s6, 1
  s_lshl_b32 s80, s80, 1
  s_lshr_b32 s81, s6, 1
  s_add_u32 s80, s80, s81
  s_lshl_b32 s80, s80, 12
  s_add_u32 s80, s80, 106496
  v_add_u32 v24, s80, v1
  v_xor_b32 v25, 0x1000, v24
  s_mov_b32 s82, 786432
  s_lshl_b32 s89, s86, 12
  s_add_u32 s89, s89, s82
  s_and_b32 s81, s5, 7
  s_lshl_b32 s81, s81, 9
  s_add_u32 s89, s89, s81
  s_lshr_b32 s81, s6, 1
  s_lshl_b32 s81, s81, 3
  s_add_u32 s89, s89, s81
  s_lshl_b32 s90, s87, 7
  s_add_u32 s90, s90, s47
  s_and_b32 s81, s5, 7
  s_lshl_b32 s81, s81, 3
  s_add_u32 s90, s90, s81
  s_lshr_b32 s81, s6, 1
  s_lshl_b32 s81, s81, 2
  s_add_u32 s90, s90, s81
  s_add_u32 s90, s90, 2048
  s_lshl_b32 s88, s86, 15
  s_and_b32 s81, s5, 7
  s_lshl_b32 s81, s81, 12
  s_add_u32 s88, s88, s81
  s_lshr_b32 s81, s6, 1
  s_lshl_b32 s81, s81, 11
  s_add_u32 s88, s88, s81
  s_add_u32 s88, s88, 4194304
  s_mov_b32 s36, s40
  s_and_b32 s37, s41, 0xffff
  s_mov_b32 s38, 1024
  s_mov_b32 s39, 0x20000
  s_and_b32 s80, s5, 7
  s_lshl_b32 s80, s80, 7
  s_lshr_b32 s81, s6, 1
  s_lshl_b32 s81, s81, 6
  s_add_u32 s80, s80, s81
  v_lshrrev_b32 v16, 5, v0
  v_lshlrev_b32 v16, 3, v16
  buffer_load_dwordx2 v[112:113], v16, s[36:39], s80 offen offset:0
  buffer_load_dwordx2 v[114:115], v16, s[36:39], s80 offen offset:16
  buffer_load_dwordx2 v[116:117], v16, s[36:39], s80 offen offset:32
  buffer_load_dwordx2 v[118:119], v16, s[36:39], s80 offen offset:48
  s_lshl_b32 s80, s87, 7
  s_add_u32 s80, s80, s47
  s_add_u32 s80, s80, 1536
  s_mov_b32 s99, 0
POLL_56:
  buffer_load_dword v16, v10, s[28:31], s80 offen sc1
  s_add_u32 s99, s99, 1
  s_cmp_gt_u32 s99, 100000
  s_cbranch_scc1 L_BAIL
  s_waitcnt vmcnt(0)
  v_cmp_gt_u32 vcc, s46, v16
  s_cbranch_vccnz POLL_56
POLLOK_57:
  s_mul_i32 s80, s86, 114688
  s_mul_i32 s81, s3, 7340032
  s_add_u32 s80, s80, s81
  s_lshr_b32 s81, s6, 1
  s_lshl_b32 s81, s81, 10
  s_add_u32 s80, s80, s81
  s_add_u32 s85, s80, 23068672
  buffer_load_dwordx4 v[128:131], v1, s[28:31], s85 offen offset:0 sc1
  buffer_load_dwordx4 v[132:135], v1, s[28:31], s85 offen offset:2048 sc1
  s_add_u32 s85, s85, 4096
  buffer_load_dwordx4 v[136:139], v1, s[28:31], s85 offen offset:0 sc1
  buffer_load_dwordx4 v[140:143], v1, s[28:31], s85 offen offset:2048 sc1
  s_add_u32 s85, s85, 4096
  buffer_load_dwordx4 v[144:147], v1, s[28:31], s85 offen offset:0 sc1
  buffer_load_dwordx4 v[148:151], v1, s[28:31], s85 offen offset:2048 sc1
  s_add_u32 s85, s85, 4096
  buffer_load_dwordx4 v[152:155], v1, s[28:31], s85 offen offset:0 sc1
  buffer_load_dwordx4 v[156:159], v1, s[28:31], s85 offen offset:2048 sc1
  s_add_u32 s85, s85, 4096
  buffer_load_dwordx4 v[160:163], v1, s[28:31], s85 offen offset:0 sc1
  buffer_load_dwordx4 v[164:167], v1, s[28:31], s85 offen offset:2048 sc1
  s_add_u32 s85, s85, 4096
  buffer_load_dwordx4 v[168:171], v1, s[28:31], s85 offen offset:0 sc1
  buffer_load_dwordx4 v[172:175], v1, s[28:31], s85 offen offset:2048 sc1
  s_add_u32 s85, s85, 4096
  v_lshlrev_b32 v80, 16, v112
  v_and_b32 v81, 0xffff0000, v112
  v_lshlrev_b32 v82, 16, v113
  v_and_b32 v83, 0xffff0000, v113
  v_lshlrev_b32 v84, 16, v114
  v_and_b32 v85, 0xffff0000, v114
  v_lshlrev_b32 v86, 16, v115
  v_and_b32 v87, 0xffff0000, v115
  v_lshlrev_b32 v88, 16, v116
  v_and_b32 v89, 0xffff0000, v116
  v_lshlrev_b32 v90, 16, v117
  v_and_b32 v91, 0xffff0000, v117
  v_lshlrev_b32 v92, 16, v118
  v_and_b32 v93, 0xffff0000, v118
  v_lshlrev_b32 v94, 16, v119
  v_and_b32 v95, 0xffff0000, v119
  s_barrier
  ds_read_b64_tr_b16 v[48:49], v12 offset:28672
  ds_read_b64_tr_b16 v[50:51], v12 offset:29696
  ds_read_b64_tr_b16 v[52:53], v13 offset:28672
  ds_read_b64_tr_b16 v[54:55], v13 offset:29696
  ds_read_b64_tr_b16 v[56:57], v12 offset:32768
  ds_read_b64_tr_b16 v[58:59], v12 offset:33792
  ds_read_b64_tr_b16 v[60:61], v13 offset:32768
  ds_read_b64_tr_b16 v[62:63], v13 offset:33792
  ds_read_b64_tr_b16 v[64:65], v12 offset:36864
  ds_read_b64_tr_b16 v[66:67], v12 offset:37888
  ds_read_b64_tr_b16 v[68:69], v13 offset:36864
  ds_read_b64_tr_b16 v[70:71], v13 offset:37888
  s_waitcnt vmcnt(11) lgkmcnt(8)
  v_mfma_f32_32x32x16_bf16 v[80:95], v[48:51], v[128:131], v[80:95]
  ds_read_b64_tr_b16 v[72:73], v12 offset:40960
  ds_read_b64_tr_b16 v[74:75], v12 offset:41984
  ds_read_b64_tr_b16 v[76:77], v13 offset:40960
  ds_read_b64_tr_b16 v[78:79], v13 offset:41984
  v_mfma_f32_32x32x16_bf16 v[96:111], v[52:55], v[128:131], 0
  buffer_load_dwordx4 v[176:179], v1, s[28:31], s85 offen offset:0 sc1
  s_waitcnt vmcnt(11) lgkmcnt(8)
  v_mfma_f32_32x32x16_bf16 v[80:95], v[56:59], v[132:135], v[80:95]
  ds_read_b64_tr_b16 v[48:49], v12 offset:45056
  ds_read_b64_tr_b16 v[50:51], v12 offset:46080
  ds_read_b64_tr_b16 v[52:53], v13 offset:45056
  ds_read_b64_tr_b16 v[54:55], v13 offset:46080
  v_mfma_f32_32x32x16_bf16 v[96:111], v[60:63], v[132:135], v[96:111]
  buffer_load_dwordx4 v[180:183], v1, s[28:31], s85 offen offset:2048 sc1
  s_add_u32 s85, s85, 4096
  s_waitcnt vmcnt(11) lgkmcnt(8)
  v_mfma_f32_32x32x16_bf16 v[80:95], v[64:67], v[136:139], v[80:95]
  ds_read_b64_tr_b16 v[56:57], v12 offset:49152
  ds_read_b64_tr_b16 v[58:59], v12 offset:50176
  ds_read_b64_tr_b16 v[60:61], v13 offset:49152
  ds_read_b64_tr_b16 v[62:63], v13 offset:50176
  v_mfma_f32_32x32x16_bf16 v[96:111], v[68:71], v[136:139], v[96:111]
  buffer_load_dwordx4 v[184:187], v1, s[28:31], s85 offen offset:0 sc1
  s_waitcnt vmcnt(11) lgkmcnt(8)
  v_mfma_f32_32x32x16_bf16 v[80:95], v[72:75], v[140:143], v[80:95]
  ds_read_b64_tr_b16 v[64:65], v12 offset:53248
  ds_read_b64_tr_b16 v[66:67], v12 offset:54272
  ds_read_b64_tr_b16 v[68:69], v13 offset:53248
  ds_read_b64_tr_b16 v[70:71], v13 offset:54272
  v_mfma_f32_32x32x16_bf16 v[96:111], v[76:79], v[140:143], v[96:111]
  buffer_load_dwordx4 v[188:191], v1, s[28:31], s85 offen offset:2048 sc1
  s_add_u32 s85, s85, 4096
  s_waitcnt vmcnt(11) lgkmcnt(8)
  v_mfma_f32_32x32x16_bf16 v[80:95], v[48:51], v[144:147], v[80:95]
  ds_read_b64_tr_b16 v[72:73], v12 offset:57344
  ds_read_b64_tr_b16 v[74:75], v12 offset:58368
  ds_read_b64_tr_b16 v[76:77], v13 offset:57344
  ds_read_b64_tr_b16 v[78:79], v13 offset:58368
  v_mfma_f32_32x32x16_bf16 v[96:111], v[52:55], v[144:147], v[96:111]
  buffer_load_dwordx4 v[192:195], v1, s[28:31], s85 offen offset:0 sc1
  s_waitcnt vmcnt(11) lgkmcnt(8)
  v_mfma_f32_32x32x16_bf16 v[80:95], v[56:59], v[148:151], v[80:95]
  ds_read_b64_tr_b16 v[48:49], v12 offset:61440
  ds_read_b64_tr_b16 v[50:51], v12 offset:62464
  ds_read_b64_tr_b16 v[52:53], v13 offset:61440
  ds_read_b64_tr_b16 v[54:55], v13 offset:62464
  v_mfma_f32_32x32x16_bf16 v[96:111], v[60:63], v[148:151], v[96:111]
  buffer_load_dwordx4 v[196:199], v1, s[28:31], s85 offen offset:2048 sc1
  s_add_u32 s85, s85, 4096
  s_waitcnt vmcnt(11) lgkmcnt(8)
  v_mfma_f32_32x32x16_bf16 v[80:95], v[64:67], v[152:155], v[80:95]
  ds_read_b64_tr_b16 v[56:57], v14 offset:0
  ds_read_b64_tr_b16 v[58:59], v14 offset:1024
  ds_read_b64_tr_b16 v[60:61], v15 offset:0
  ds_read_b64_tr_b16 v[62:63], v15 offset:1024
  v_mfma_f32_32x32x16_bf16 v[96:111], v[68:71], v[152:155], v[96:111]
  buffer_load_dwordx4 v[200:203], v1, s[28:31], s85 offen offset:0 sc1
  s_waitcnt vmcnt(11) lgkmcnt(8)
  v_mfma_f32_32x32x16_bf16 v[80:95], v[72:75], v[156:159], v[80:95]
  ds_read_b64_tr_b16 v[64:65], v14 offset:4096
  ds_read_b64_tr_b16 v[66:67], v14 offset:5120
  ds_read_b64_tr_b16 v[68:69], v15 offset:4096
  ds_read_b64_tr_b16 v[70:71], v15 offset:5120
  v_mfma_f32_32x32x16_bf16 v[96:111], v[76:79], v[156:159], v[96:111]
  buffer_load_dwordx4 v[204:207], v1, s[28:31], s85 offen offset:2048 sc1
  s_add_u32 s85, s85, 4096
  s_waitcnt vmcnt(11) lgkmcnt(8)
  v_mfma_f32_32x32x16_bf16 v[80:95], v[48:51], v[160:163], v[80:95]
  ds_read_b64_tr_b16 v[72:73], v14 offset:8192
  ds_read_b64_tr_b16 v[74:75], v14 offset:9216
  ds_read_b64_tr_b16 v[76:77], v15 offset:8192
  ds_read_b64_tr_b16 v[78:79], v15 offset:9216
  v_mfma_f32_32x32x16_bf16 v[96:111], v[52:55], v[160:163], v[96:111]
  buffer_load_dwordx4 v[208:211], v1, s[28:31], s85 offen offset:0 sc1
  s_waitcnt vmcnt(11) lgkmcnt(8)
  v_mfma_f32_32x32x16_bf16 v[80:95], v[56:59], v[164:167], v[80:95]
  ds_read_b64_tr_b16 v[48:49], v14 offset:12288
  ds_read_b64_tr_b16 v[50:51], v14 offset:13312
  ds_read_b64_tr_b16 v[52:53], v15 offset:12288
  ds_read_b64_tr_b16 v[54:55], v15 offset:13312
  v_mfma_f32_32x32x16_bf16 v[96:111], v[60:63], v[164:167], v[96:111]
  buffer_load_dwordx4 v[212:215], v1, s[28:31], s85 offen offset:2048 sc1
  s_add_u32 s85, s85, 4096
  s_waitcnt vmcnt(11) lgkmcnt(8)
  v_mfma_f32_32x32x16_bf16 v[80:95], v[64:67], v[168:171], v[80:95]
  ds_read_b64_tr_b16 v[56:57], v14 offset:16384
  ds_read_b64_tr_b16 v[58:59], v14 offset:17408
  ds_read_b64_tr_b16 v[60:61], v15 offset:16384
  ds_read_b64_tr_b16 v[62:63], v15 offset:17408
  v_mfma_f32_32x32x16_bf16 v[96:111], v[68:71], v[168:171], v[96:111]
  buffer_load_dwordx4 v[216:219], v1, s[28:31], s85 offen offset:0 sc1
  s_waitcnt vmcnt(11) lgkmcnt(8)
  v_mfma_f32_32x32x16_bf16 v[80:95], v[72:75], v[172:175], v[80:95]
  ds_read_b64_tr_b16 v[64:65], v14 offset:20480
  ds_read_b64_tr_b16 v[66:67], v14 offset:21504
  ds_read_b64_tr_b16 v[68:69], v15 offset:20480
  ds_read_b64_tr_b16 v[70:71], v15 offset:21504
  v_mfma_f32_32x32x16_bf16 v[96:111], v[76:79], v[172:175], v[96:111]
  buffer_load_dwordx4 v[220:223], v1, s[28:31], s85 offen offset:2048 sc1
  s_add_u32 s85, s85, 4096
  s_waitcnt vmcnt(11) lgkmcnt(8)
  v_mfma_f32_32x32x16_bf16 v[80:95], v[48:51], v[176:179], v[80:95]
  ds_read_b64_tr_b16 v[72:73], v14 offset:24576
  ds_read_b64_tr_b16 v[74:75], v14 offset:25600
  ds_read_b64_tr_b16 v[76:77], v15 offset:24576
  ds_read_b64_tr_b16 v[78:79], v15 offset:25600
  v_mfma_f32_32x32x16_bf16 v[96:111], v[52:55], v[176:179], v[96:111]
  buffer_load_dwordx4 v[224:227], v1, s[28:31], s85 offen offset:0 sc1
  s_waitcnt vmcnt(11) lgkmcnt(8)
  v_mfma_f32_32x32x16_bf16 v[80:95], v[56:59], v[180:183], v[80:95]
  ds_read_b64_tr_b16 v[48:49], v14 offset:28672
  ds_read_b64_tr_b16 v[50:51], v14 offset:29696
  ds_read_b64_tr_b16 v[52:53], v15 offset:28672
  ds_read_b64_tr_b16 v[54:55], v15 offset:29696
  v_mfma_f32_32x32x16_bf16 v[96:111], v[60:63], v[180:183], v[96:111]
  buffer_load_dwordx4 v[228:231], v1, s[28:31], s85 offen offset:2048 sc1
  s_add_u32 s85, s85, 4096
  s_waitcnt vmcnt(11) lgkmcnt(8)
  v_mfma_f32_32x32x16_bf16 v[80:95], v[64:67], v[184:187], v[80:95]
  ds_read_b64_tr_b16 v[56:57], v14 offset:32768
  ds_read_b64_tr_b16 v[58:59], v14 offset:33792
  ds_read_b64_tr_b16 v[60:61], v15 offset:32768
  ds_read_b64_tr_b16 v[62:63], v15 offset:33792
  v_mfma_f32_32x32x16_bf16 v[96:111], v[68:71], v[184:187], v[96:111]
  buffer_load_dwordx4 v[232:235], v1, s[28:31], s85 offen offset:0 sc1
  s_waitcnt vmcnt(11) lgkmcnt(8)
  v_mfma_f32_32x32x16_bf16 v[80:95], v[72:75], v[188:191], v[80:95]
  ds_read_b64_tr_b16 v[64:65], v14 offset:36864
  ds_read_b64_tr_b16 v[66:67], v14 offset:37888
  ds_read_b64_tr_b16 v[68:69], v15 offset:36864
  ds_read_b64_tr_b16 v[70:71], v15 offset:37888
  v_mfma_f32_32x32x16_bf16 v[96:111], v[76:79], v[188:191], v[96:111]
  buffer_load_dwordx4 v[236:239], v1, s[28:31], s85 offen offset:2048 sc1
  s_add_u32 s85, s85, 4096
  s_waitcnt vmcnt(11) lgkmcnt(8)
  v_mfma_f32_32x32x16_bf16 v[80:95], v[48:51], v[192:195], v[80:95]
  ds_read_b64_tr_b16 v[72:73], v14 offset:40960
  ds_read_b64_tr_b16 v[74:75], v14 offset:41984
  ds_read_b64_tr_b16 v[76:77], v15 offset:40960
  ds_read_b64_tr_b16 v[78:79], v15 offset:41984
  v_mfma_f32_32x32x16_bf16 v[96:111], v[52:55], v[192:195], v[96:111]
  buffer_load_dwordx4 v[240:243], v1, s[28:31], s85 offen offset:0 sc1
  s_barrier
  s_waitcnt vmcnt(11) lgkmcnt(8)
  v_mfma_f32_32x32x16_bf16 v[80:95], v[56:59], v[196:199], v[80:95]
  ds_read_b64_tr_b16 v[48:49], v14 offset:45056
  ds_read_b64_tr_b16 v[50:51], v14 offset:46080
  ds_read_b64_tr_b16 v[52:53], v15 offset:45056
  ds_read_b64_tr_b16 v[54:55], v15 offset:46080
  v_mfma_f32_32x32x16_bf16 v[96:111], v[60:63], v[196:199], v[96:111]
  buffer_load_dwordx4 v[244:247], v1, s[28:31], s85 offen offset:2048 sc1
  s_add_u32 s85, s85, 4096
  s_waitcnt vmcnt(11) lgkmcnt(8)
  v_mfma_f32_32x32x16_bf16 v[80:95], v[64:67], v[200:203], v[80:95]
  ds_read_b64_tr_b16 v[56:57], v14 offset:49152
  ds_read_b64_tr_b16 v[58:59], v14 offset:50176
  ds_read_b64_tr_b16 v[60:61], v15 offset:49152
  ds_read_b64_tr_b16 v[62:63], v15 offset:50176
  v_mfma_f32_32x32x16_bf16 v[96:111], v[68:71], v[200:203], v[96:111]
  buffer_load_dwordx4 v[248:251], v1, s[28:31], s85 offen offset:0 sc1
  s_waitcnt vmcnt(11) lgkmcnt(8)
  v_mfma_f32_32x32x16_bf16 v[80:95], v[72:75], v[204:207], v[80:95]
  ds_read_b64_tr_b16 v[64:65], v14 offset:53248
  ds_read_b64_tr_b16 v[66:67], v14 offset:54272
  ds_read_b64_tr_b16 v[68:69], v15 offset:53248
  ds_read_b64_tr_b16 v[70:71], v15 offset:54272
  v_mfma_f32_32x32x16_bf16 v[96:111], v[76:79], v[204:207], v[96:111]
  buffer_load_dwordx4 v[252:255], v1, s[28:31], s85 offen offset:2048 sc1
  s_add_u32 s85, s85, 4096
  s_waitcnt vmcnt(11) lgkmcnt(8)
  v_mfma_f32_32x32x16_bf16 v[80:95], v[48:51], v[208:211], v[80:95]
  ds_read_b64_tr_b16 v[72:73], v14 offset:57344
  ds_read_b64_tr_b16 v[74:75], v14 offset:58368
  ds_read_b64_tr_b16 v[76:77], v15 offset:57344
  ds_read_b64_tr_b16 v[78:79], v15 offset:58368
  v_mfma_f32_32x32x16_bf16 v[96:111], v[52:55], v[208:211], v[96:111]
  buffer_load_dwordx4 v[128:131], v1, s[28:31], s85 offen offset:0 sc1
  s_waitcnt vmcnt(11) lgkmcnt(8)
  v_mfma_f32_32x32x16_bf16 v[80:95], v[56:59], v[212:215], v[80:95]
  ds_read_b64_tr_b16 v[48:49], v14 offset:61440
  ds_read_b64_tr_b16 v[50:51], v14 offset:62464
  ds_read_b64_tr_b16 v[52:53], v15 offset:61440
  ds_read_b64_tr_b16 v[54:55], v15 offset:62464
  v_mfma_f32_32x32x16_bf16 v[96:111], v[60:63], v[212:215], v[96:111]
  buffer_load_dwordx4 v[132:135], v1, s[28:31], s85 offen offset:2048 sc1
  s_add_u32 s85, s85, 4096
  s_waitcnt vmcnt(11) lgkmcnt(8)
  v_mfma_f32_32x32x16_bf16 v[80:95], v[64:67], v[216:219], v[80:95]
  ds_read_b64_tr_b16 v[56:57], v22 offset:0
  ds_read_b64_tr_b16 v[58:59], v22 offset:1024
  ds_read_b64_tr_b16 v[60:61], v23 offset:0
  ds_read_b64_tr_b16 v[62:63], v23 offset:1024
  v_mfma_f32_32x32x16_bf16 v[96:111], v[68:71], v[216:219], v[96:111]
  buffer_load_dwordx4 v[136:139], v1, s[28:31], s85 offen offset:0 sc1
  s_waitcnt vmcnt(11) lgkmcnt(8)
  v_mfma_f32_32x32x16_bf16 v[80:95], v[72:75], v[220:223], v[80:95]
  ds_read_b64_tr_b16 v[64:65], v22 offset:4096
  ds_read_b64_tr_b16 v[66:67], v22 offset:5120
  ds_read_b64_tr_b16 v[68:69], v23 offset:4096
  ds_read_b64_tr_b16 v[70:71], v23 offset:5120
  v_mfma_f32_32x32x16_bf16 v[96:111], v[76:79], v[220:223], v[96:111]
  buffer_load_dwordx4 v[140:143], v1, s[28:31], s85 offen offset:2048 sc1
  s_add_u32 s85, s85, 4096
  s_waitcnt vmcnt(11) lgkmcnt(8)
  v_mfma_f32_32x32x16_bf16 v[80:95], v[48:51], v[224:227], v[80:95]
  ds_read_b64_tr_b16 v[72:73], v22 offset:8192
  ds_read_b64_tr_b16 v[74:75], v22 offset:9216
  ds_read_b64_tr_b16 v[76:77], v23 offset:8192
  ds_read_b64_tr_b16 v[78:79], v23 offset:9216
  v_mfma_f32_32x32x16_bf16 v[96:111], v[52:55], v[224:227], v[96:111]
  buffer_load_dwordx4 v[144:147], v1, s[28:31], s85 offen offset:0 sc1
  s_waitcnt vmcnt(11) lgkmcnt(8)
  v_mfma_f32_32x32x16_bf16 v[80:95], v[56:59], v[228:231], v[80:95]
  ds_read_b64_tr_b16 v[48:49], v22 offset:12288
  ds_read_b64_tr_b16 v[50:51], v22 offset:13312
  ds_read_b64_tr_b16 v[52:53], v23 offset:12288
  ds_read_b64_tr_b16 v[54:55], v23 offset:13312
  v_mfma_f32_32x32x16_bf16 v[96:111], v[60:63], v[228:231], v[96:111]
  buffer_load_dwordx4 v[148:151], v1, s[28:31], s85 offen offset:2048 sc1
  s_add_u32 s85, s85, 4096
  s_waitcnt vmcnt(11) lgkmcnt(8)
  v_mfma_f32_32x32x16_bf16 v[80:95], v[64:67], v[232:235], v[80:95]
  ds_read_b64_tr_b16 v[56:57], v22 offset:16384
  ds_read_b64_tr_b16 v[58:59], v22 offset:17408
  ds_read_b64_tr_b16 v[60:61], v23 offset:16384
  ds_read_b64_tr_b16 v[62:63], v23 offset:17408
  v_mfma_f32_32x32x16_bf16 v[96:111], v[68:71], v[232:235], v[96:111]
  buffer_load_dwordx4 v[152:155], v1, s[28:31], s85 offen offset:0 sc1
  s_waitcnt vmcnt(11) lgkmcnt(8)
  v_mfma_f32_32x32x16_bf16 v[80:95], v[72:75], v[236:239], v[80:95]
  ds_read_b64_tr_b16 v[64:65], v22 offset:20480
  ds_read_b64_tr_b16 v[66:67], v22 offset:21504
  ds_read_b64_tr_b16 v[68:69], v23 offset:20480
  ds_read_b64_tr_b16 v[70:71], v23 offset:21504
  v_mfma_f32_32x32x16_bf16 v[96:111], v[76:79], v[236:239], v[96:111]
  buffer_load_dwordx4 v[156:159], v1, s[28:31], s85 offen offset:2048 sc1
  s_add_u32 s85, s85, 4096
  s_waitcnt vmcnt(11) lgkmcnt(8)
  v_mfma_f32_32x32x16_bf16 v[80:95], v[48:51], v[240:243], v[80:95]
  ds_read_b64_tr_b16 v[72:73], v22 offset:24576
  ds_read_b64_tr_b16 v[74:75], v22 offset:25600
  ds_read_b64_tr_b16 v[76:77], v23 offset:24576
  ds_read_b64_tr_b16 v[78:79], v23 offset:25600
  v_mfma_f32_32x32x16_bf16 v[96:111], v[52:55], v[240:243], v[96:111]
  buffer_load_dwordx4 v[160:163], v1, s[28:31], s85 offen offset:0 sc1
  s_waitcnt vmcnt(11) lgkmcnt(8)
  v_mfma_f32_32x32x16_bf16 v[80:95], v[56:59], v[244:247], v[80:95]
  ds_read_b64_tr_b16 v[48:49], v12 offset:0
  ds_read_b64_tr_b16 v[50:51], v12 offset:1024
  ds_read_b64_tr_b16 v[52:53], v13 offset:0
  ds_read_b64_tr_b16 v[54:55], v13 offset:1024
  v_mfma_f32_32x32x16_bf16 v[96:111], v[60:63], v[244:247], v[96:111]
  buffer_load_dwordx4 v[164:167], v1, s[28:31], s85 offen offset:2048 sc1
  s_add_u32 s85, s85, 4096
  s_waitcnt vmcnt(11) lgkmcnt(8)
  v_mfma_f32_32x32x16_bf16 v[80:95], v[64:67], v[248:251], v[80:95]
  ds_read_b64_tr_b16 v[56:57], v12 offset:4096
  ds_read_b64_tr_b16 v[58:59], v12 offset:5120
  ds_read_b64_tr_b16 v[60:61], v13 offset:4096
  ds_read_b64_tr_b16 v[62:63], v13 offset:5120
  v_mfma_f32_32x32x16_bf16 v[96:111], v[68:71], v[248:251], v[96:111]
  buffer_load_dwordx4 v[168:171], v1, s[28:31], s85 offen offset:0 sc1
  s_waitcnt vmcnt(11) lgkmcnt(8)
  v_mfma_f32_32x32x16_bf16 v[80:95], v[72:75], v[252:255], v[80:95]
  ds_read_b64_tr_b16 v[64:65], v12 offset:8192
  ds_read_b64_tr_b16 v[66:67], v12 offset:9216
  ds_read_b64_tr_b16 v[68:69], v13 offset:8192
  ds_read_b64_tr_b16 v[70:71], v13 offset:9216
  v_mfma_f32_32x32x16_bf16 v[96:111], v[76:79], v[252:255], v[96:111]
  buffer_load_dwordx4 v[172:175], v1, s[28:31], s85 offen offset:2048 sc1
  s_add_u32 s85, s85, 4096
  s_waitcnt vmcnt(11) lgkmcnt(8)
  v_mfma_f32_32x32x16_bf16 v[80:95], v[48:51], v[128:131], v[80:95]
  ds_read_b64_tr_b16 v[72:73], v12 offset:12288
  ds_read_b64_tr_b16 v[74:75], v12 offset:13312
  ds_read_b64_tr_b16 v[76:77], v13 offset:12288
  ds_read_b64_tr_b16 v[78:79], v13 offset:13312
  v_mfma_f32_32x32x16_bf16 v[96:111], v[52:55], v[128:131], v[96:111]
  buffer_load_dwordx4 v[176:179], v1, s[28:31], s85 offen offset:0 sc1
  s_waitcnt vmcnt(11) lgkmcnt(8)
  v_mfma_f32_32x32x16_bf16 v[80:95], v[56:59], v[132:135], v[80:95]
  ds_read_b64_tr_b16 v[48:49], v12 offset:16384
  ds_read_b64_tr_b16 v[50:51], v12 offset:17408
  ds_read_b64_tr_b16 v[52:53], v13 offset:16384
  ds_read_b64_tr_b16 v[54:55], v13 offset:17408
  v_mfma_f32_32x32x16_bf16 v[96:111], v[60:63], v[132:135], v[96:111]
  buffer_load_dwordx4 v[180:183], v1, s[28:31], s85 offen offset:2048 sc1
  s_add_u32 s85, s85, 4096
  s_waitcnt vmcnt(11) lgkmcnt(8)
  v_mfma_f32_32x32x16_bf16 v[80:95], v[64:67], v[136:139], v[80:95]
  ds_read_b64_tr_b16 v[56:57], v12 offset:20480
  ds_read_b64_tr_b16 v[58:59], v12 offset:21504
  ds_read_b64_tr_b16 v[60:61], v13 offset:20480
  ds_read_b64_tr_b16 v[62:63], v13 offset:21504
  v_mfma_f32_32x32x16_bf16 v[96:111], v[68:71], v[136:139], v[96:111]
  buffer_load_dwordx4 v[184:187], v1, s[28:31], s85 offen offset:0 sc1
  s_waitcnt vmcnt(11) lgkmcnt(8)
  v_mfma_f32_32x32x16_bf16 v[80:95], v[72:75], v[140:143], v[80:95]
  ds_read_b64_tr_b16 v[64:65], v12 offset:24576
  ds_read_b64_tr_b16 v[66:67], v12 offset:25600
  ds_read_b64_tr_b16 v[68:69], v13 offset:24576
  ds_read_b64_tr_b16 v[70:71], v13 offset:25600
  v_mfma_f32_32x32x16_bf16 v[96:111], v[76:79], v[140:143], v[96:111]
  buffer_load_dwordx4 v[188:191], v1, s[28:31], s85 offen offset:2048 sc1
  s_add_u32 s85, s85, 4096
  s_barrier
  s_waitcnt vmcnt(11) lgkmcnt(8)
  v_mfma_f32_32x32x16_bf16 v[80:95], v[48:51], v[144:147], v[80:95]
  ds_read_b64_tr_b16 v[72:73], v12 offset:28672
  ds_read_b64_tr_b16 v[74:75], v12 offset:29696
  ds_read_b64_tr_b16 v[76:77], v13 offset:28672
  ds_read_b64_tr_b16 v[78:79], v13 offset:29696
  v_mfma_f32_32x32x16_bf16 v[96:111], v[52:55], v[144:147], v[96:111]
  buffer_load_dwordx4 v[192:195], v1, s[28:31], s85 offen offset:0 sc1
  s_waitcnt vmcnt(11) lgkmcnt(8)
  v_mfma_f32_32x32x16_bf16 v[80:95], v[56:59], v[148:151], v[80:95]
  ds_read_b64_tr_b16 v[48:49], v12 offset:32768
  ds_read_b64_tr_b16 v[50:51], v12 offset:33792
  ds_read_b64_tr_b16 v[52:53], v13 offset:32768
  ds_read_b64_tr_b16 v[54:55], v13 offset:33792
  v_mfma_f32_32x32x16_bf16 v[96:111], v[60:63], v[148:151], v[96:111]
  buffer_load_dwordx4 v[196:199], v1, s[28:31], s85 offen offset:2048 sc1
  s_add_u32 s85, s85, 4096
  s_waitcnt vmcnt(11) lgkmcnt(8)
  v_mfma_f32_32x32x16_bf16 v[80:95], v[64:67], v[152:155], v[80:95]
  ds_read_b64_tr_b16 v[56:57], v12 offset:36864
  ds_read_b64_tr_b16 v[58:59], v12 offset:37888
  ds_read_b64_tr_b16 v[60:61], v13 offset:36864
  ds_read_b64_tr_b16 v[62:63], v13 offset:37888
  v_mfma_f32_32x32x16_bf16 v[96:111], v[68:71], v[152:155], v[96:111]
  buffer_load_dwordx4 v[200:203], v1, s[28:31], s85 offen offset:0 sc1
  s_waitcnt vmcnt(11) lgkmcnt(8)
  v_mfma_f32_32x32x16_bf16 v[80:95], v[72:75], v[156:159], v[80:95]
  ds_read_b64_tr_b16 v[64:65], v12 offset:40960
  ds_read_b64_tr_b16 v[66:67], v12 offset:41984
  ds_read_b64_tr_b16 v[68:69], v13 offset:40960
  ds_read_b64_tr_b16 v[70:71], v13 offset:41984
  v_mfma_f32_32x32x16_bf16 v[96:111], v[76:79], v[156:159], v[96:111]
  buffer_load_dwordx4 v[204:207], v1, s[28:31], s85 offen offset:2048 sc1
  s_add_u32 s85, s85, 4096
  s_waitcnt vmcnt(11) lgkmcnt(8)
  v_mfma_f32_32x32x16_bf16 v[80:95], v[48:51], v[160:163], v[80:95]
  ds_read_b64_tr_b16 v[72:73], v12 offset:45056
  ds_read_b64_tr_b16 v[74:75], v12 offset:46080
  ds_read_b64_tr_b16 v[76:77], v13 offset:45056
  ds_read_b64_tr_b16 v[78:79], v13 offset:46080
  v_mfma_f32_32x32x16_bf16 v[96:111], v[52:55], v[160:163], v[96:111]
  buffer_load_dwordx4 v[208:211], v1, s[28:31], s85 offen offset:0 sc1
  s_waitcnt vmcnt(11) lgkmcnt(8)
  v_mfma_f32_32x32x16_bf16 v[80:95], v[56:59], v[164:167], v[80:95]
  ds_read_b64_tr_b16 v[48:49], v12 offset:49152
  ds_read_b64_tr_b16 v[50:51], v12 offset:50176
  ds_read_b64_tr_b16 v[52:53], v13 offset:49152
  ds_read_b64_tr_b16 v[54:55], v13 offset:50176
  v_mfma_f32_32x32x16_bf16 v[96:111], v[60:63], v[164:167], v[96:111]
  buffer_load_dwordx4 v[212:215], v1, s[28:31], s85 offen offset:2048 sc1
  s_add_u32 s85, s85, 4096
  s_waitcnt vmcnt(11) lgkmcnt(8)
  v_mfma_f32_32x32x16_bf16 v[80:95], v[64:67], v[168:171], v[80:95]
  ds_read_b64_tr_b16 v[56:57], v12 offset:53248
  ds_read_b64_tr_b16 v[58:59], v12 offset:54272
  ds_read_b64_tr_b16 v[60:61], v13 offset:53248
  ds_read_b64_tr_b16 v[62:63], v13 offset:54272
  v_mfma_f32_32x32x16_bf16 v[96:111], v[68:71], v[168:171], v[96:111]
  buffer_load_dwordx4 v[216:219], v1, s[28:31], s85 offen offset:0 sc1
  s_waitcnt vmcnt(11) lgkmcnt(8)
  v_mfma_f32_32x32x16_bf16 v[80:95], v[72:75], v[172:175], v[80:95]
  ds_read_b64_tr_b16 v[64:65], v12 offset:57344
  ds_read_b64_tr_b16 v[66:67], v12 offset:58368
  ds_read_b64_tr_b16 v[68:69], v13 offset:57344
  ds_read_b64_tr_b16 v[70:71], v13 offset:58368
  v_mfma_f32_32x32x16_bf16 v[96:111], v[76:79], v[172:175], v[96:111]
  buffer_load_dwordx4 v[220:223], v1, s[28:31], s85 offen offset:2048 sc1
  s_add_u32 s85, s85, 4096
  s_waitcnt vmcnt(11) lgkmcnt(8)
  v_mfma_f32_32x32x16_bf16 v[80:95], v[48:51], v[176:179], v[80:95]
  ds_read_b64_tr_b16 v[72:73], v12 offset:61440
  ds_read_b64_tr_b16 v[74:75], v12 offset:62464
  ds_read_b64_tr_b16 v[76:77], v13 offset:61440
  ds_read_b64_tr_b16 v[78:79], v13 offset:62464
  v_mfma_f32_32x32x16_bf16 v[96:111], v[52:55], v[176:179], v[96:111]
  s_waitcnt vmcnt(10) lgkmcnt(8)
  v_mfma_f32_32x32x16_bf16 v[80:95], v[56:59], v[180:183], v[80:95]
  ds_read_b64_tr_b16 v[48:49], v14 offset:0
  ds_read_b64_tr_b16 v[50:51], v14 offset:1024
  ds_read_b64_tr_b16 v[52:53], v15 offset:0
  ds_read_b64_tr_b16 v[54:55], v15 offset:1024
  v_mfma_f32_32x32x16_bf16 v[96:111], v[60:63], v[180:183], v[96:111]
  s_waitcnt vmcnt(9) lgkmcnt(8)
  v_mfma_f32_32x32x16_bf16 v[80:95], v[64:67], v[184:187], v[80:95]
  ds_read_b64_tr_b16 v[56:57], v14 offset:4096
  ds_read_b64_tr_b16 v[58:59], v14 offset:5120
  ds_read_b64_tr_b16 v[60:61], v15 offset:4096
  ds_read_b64_tr_b16 v[62:63], v15 offset:5120
  v_mfma_f32_32x32x16_bf16 v[96:111], v[68:71], v[184:187], v[96:111]
  s_waitcnt vmcnt(8) lgkmcnt(8)
  v_mfma_f32_32x32x16_bf16 v[80:95], v[72:75], v[188:191], v[80:95]
  ds_read_b64_tr_b16 v[64:65], v14 offset:8192
  ds_read_b64_tr_b16 v[66:67], v14 offset:9216
  ds_read_b64_tr_b16 v[68:69], v15 offset:8192
  ds_read_b64_tr_b16 v[70:71], v15 offset:9216
  v_mfma_f32_32x32x16_bf16 v[96:111], v[76:79], v[188:191], v[96:111]
  s_waitcnt vmcnt(7) lgkmcnt(8)
  v_mfma_f32_32x32x16_bf16 v[80:95], v[48:51], v[192:195], v[80:95]
  ds_read_b64_tr_b16 v[72:73], v14 offset:12288
  ds_read_b64_tr_b16 v[74:75], v14 offset:13312
  ds_read_b64_tr_b16 v[76:77], v15 offset:12288
  ds_read_b64_tr_b16 v[78:79], v15 offset:13312
  v_mfma_f32_32x32x16_bf16 v[96:111], v[52:55], v[192:195], v[96:111]
  s_waitcnt vmcnt(6) lgkmcnt(8)
  v_mfma_f32_32x32x16_bf16 v[80:95], v[56:59], v[196:199], v[80:95]
  ds_read_b64_tr_b16 v[48:49], v14 offset:16384
  ds_read_b64_tr_b16 v[50:51], v14 offset:17408
  ds_read_b64_tr_b16 v[52:53], v15 offset:16384
  ds_read_b64_tr_b16 v[54:55], v15 offset:17408
  v_mfma_f32_32x32x16_bf16 v[96:111], v[60:63], v[196:199], v[96:111]
  s_waitcnt vmcnt(5) lgkmcnt(8)
  v_mfma_f32_32x32x16_bf16 v[80:95], v[64:67], v[200:203], v[80:95]
  ds_read_b64_tr_b16 v[56:57], v14 offset:20480
  ds_read_b64_tr_b16 v[58:59], v14 offset:21504
  ds_read_b64_tr_b16 v[60:61], v15 offset:20480
  ds_read_b64_tr_b16 v[62:63], v15 offset:21504
  v_mfma_f32_32x32x16_bf16 v[96:111], v[68:71], v[200:203], v[96:111]
  s_waitcnt vmcnt(4) lgkmcnt(8)
  v_mfma_f32_32x32x16_bf16 v[80:95], v[72:75], v[204:207], v[80:95]
  ds_read_b64_tr_b16 v[64:65], v14 offset:24576
  ds_read_b64_tr_b16 v[66:67], v14 offset:25600
  ds_read_b64_tr_b16 v[68:69], v15 offset:24576
  ds_read_b64_tr_b16 v[70:71], v15 offset:25600
  v_mfma_f32_32x32x16_bf16 v[96:111], v[76:79], v[204:207], v[96:111]
  s_waitcnt vmcnt(3) lgkmcnt(8)
  v_mfma_f32_32x32x16_bf16 v[80:95], v[48:51], v[208:211], v[80:95]
  ds_read_b64_tr_b16 v[72:73], v14 offset:28672
  ds_read_b64_tr_b16 v[74:75], v14 offset:29696
  ds_read_b64_tr_b16 v[76:77], v15 offset:28672
  ds_read_b64_tr_b16 v[78:79], v15 offset:29696
  v_mfma_f32_32x32x16_bf16 v[96:111], v[52:55], v[208:211], v[96:111]
  s_waitcnt vmcnt(2) lgkmcnt(8)
  v_mfma_f32_32x32x16_bf16 v[80:95], v[56:59], v[212:215], v[80:95]
  v_mfma_f32_32x32x16_bf16 v[96:111], v[60:63], v[212:215], v[96:111]
  s_waitcnt vmcnt(1) lgkmcnt(4)
  v_mfma_f32_32x32x16_bf16 v[80:95], v[64:67], v[216:219], v[80:95]
  v_mfma_f32_32x32x16_bf16 v[96:111], v[68:71], v[216:219], v[96:111]
  s_waitcnt vmcnt(0) lgkmcnt(0)
  v_mfma_f32_32x32x16_bf16 v[80:95], v[72:75], v[220:223], v[80:95]
  v_mfma_f32_32x32x16_bf16 v[96:111], v[76:79], v[220:223], v[96:111]
  s_nop 11
  ds_write_b128 v25, v[96:99] offset:0
  ds_write_b128 v25, v[100:103] offset:1024
  ds_write_b128 v25, v[104:107] offset:2048
  ds_write_b128 v25, v[108:111] offset:3072
  v_lshlrev_b32 v112, 16, v2
  v_and_b32 v113, 0xffff0000, v2
  v_lshlrev_b32 v114, 16, v3
  v_and_b32 v115, 0xffff0000, v3
  v_lshlrev_b32 v116, 16, v4
  v_and_b32 v117, 0xffff0000, v4
  v_lshlrev_b32 v118, 16, v5
  v_and_b32 v119, 0xffff0000, v5
  v_lshlrev_b32 v120, 16, v6
  v_and_b32 v121, 0xffff0000, v6
  v_lshlrev_b32 v122, 16, v7
  v_and_b32 v123, 0xffff0000, v7
  v_lshlrev_b32 v124, 16, v8
  v_and_b32 v125, 0xffff0000, v8
  v_lshlrev_b32 v126, 16, v9
  v_and_b32 v127, 0xffff0000, v9
  v_pk_add_f32 v[80:81], v[80:81], v[112:113]
  v_pk_add_f32 v[82:83], v[82:83], v[114:115]
  v_pk_add_f32 v[84:85], v[84:85], v[116:117]
  v_pk_add_f32 v[86:87], v[86:87], v[118:119]
  v_pk_add_f32 v[88:89], v[88:89], v[120:121]
  v_pk_add_f32 v[90:91], v[90:91], v[122:123]
  v_pk_add_f32 v[92:93], v[92:93], v[124:125]
  v_pk_add_f32 v[94:95], v[94:95], v[126:127]
  s_waitcnt lgkmcnt(0)
  s_barrier
  ds_read_b128 v[112:115], v24 offset:0
  ds_read_b128 v[116:119], v24 offset:1024
  ds_read_b128 v[120:123], v24 offset:2048
  ds_read_b128 v[124:127], v24 offset:3072
  s_waitcnt lgkmcnt(3)
  v_pk_add_f32 v[80:81], v[80:81], v[112:113]
  v_pk_add_f32 v[82:83], v[82:83], v[114:115]
  s_waitcnt lgkmcnt(2)
  v_pk_add_f32 v[84:85], v[84:85], v[116:117]
  v_pk_add_f32 v[86:87], v[86:87], v[118:119]
  s_waitcnt lgkmcnt(1)
  v_pk_add_f32 v[88:89], v[88:89], v[120:121]
  v_pk_add_f32 v[90:91], v[90:91], v[122:123]
  s_waitcnt lgkmcnt(0)
  v_pk_add_f32 v[92:93], v[92:93], v[124:125]
  v_pk_add_f32 v[94:95], v[94:95], v[126:127]
  v_cvt_pk_bf16_f32 v2, v80, v81
  v_cvt_pk_bf16_f32 v3, v82, v83
  v_cvt_pk_bf16_f32 v4, v84, v85
  v_cvt_pk_bf16_f32 v5, v86, v87
  v_cvt_pk_bf16_f32 v6, v88, v89
  v_cvt_pk_bf16_f32 v7, v90, v91
  v_cvt_pk_bf16_f32 v8, v92, v93
  v_cvt_pk_bf16_f32 v9, v94, v95
  v_pk_add_f32 v[112:113], v[80:81], v[82:83]
  v_pk_mul_f32 v[114:115], v[80:81], v[80:81]
  v_pk_fma_f32 v[114:115], v[82:83], v[82:83], v[114:115]
  v_pk_add_f32 v[112:113], v[112:113], v[84:85]
  v_pk_fma_f32 v[114:115], v[84:85], v[84:85], v[114:115]
  v_pk_add_f32 v[112:113], v[112:113], v[86:87]
  v_pk_fma_f32 v[114:115], v[86:87], v[86:87], v[114:115]
  v_pk_add_f32 v[112:113], v[112:113], v[88:89]
  v_pk_fma_f32 v[114:115], v[88:89], v[88:89], v[114:115]
  v_pk_add_f32 v[112:113], v[112:113], v[90:91]
  v_pk_fma_f32 v[114:115], v[90:91], v[90:91], v[114:115]
  v_pk_add_f32 v[112:113], v[112:113], v[92:93]
  v_pk_fma_f32 v[114:115], v[92:93], v[92:93], v[114:115]
  v_pk_add_f32 v[112:113], v[112:113], v[94:95]
  v_pk_fma_f32 v[114:115], v[94:95], v[94:95], v[114:115]
  v_add_f32 v16, v112, v113
  v_add_f32 v17, v114, v115
  v_mov_b32 v18, v16
  v_mov_b32 v19, v17
  s_nop 0
  v_permlane32_swap_b32 v16, v18
  v_permlane32_swap_b32 v17, v19
  v_add_f32 v16, v16, v18
  v_add_f32 v17, v17, v19
  s_cmp_eq_u32 s3, 1
  s_cbranch_scc1 FINAL_58
  s_cmp_eq_u32 s7, 0
  s_cbranch_scc1 SLOW_60
  buffer_store_dwordx4 v[2:5], v1, s[28:31], s88 offen
  buffer_store_dwordx4 v[6:9], v1, s[28:31], s88 offen offset:1024
  s_branch SDONE_61
SLOW_60:
  buffer_store_dwordx4 v[2:5], v1, s[28:31], s88 offen sc1
  buffer_store_dwordx4 v[6:9], v1, s[28:31], s88 offen offset:1024 sc1
SDONE_61:
  s_mov_b32 exec_hi, 0
  s_cmp_eq_u32 s7, 0
  s_cbranch_scc1 SLOW_62
  buffer_store_dwordx2 v[16:17], v1, s[28:31], s89 offen
  s_branch SDONE_63
SLOW_62:
  buffer_store_dwordx2 v[16:17], v1, s[28:31], s89 offen sc1
SDONE_63:
  s_mov_b32 exec_hi, -1
  s_waitcnt vmcnt(0)
  v_mov_b32 v18, s46
  s_mov_b64 exec, 1
  s_cmp_eq_u32 s7, 0
  s_cbranch_scc1 SLOW_64
  buffer_store_dword v18, off, s[28:31], s90
  s_branch SDONE_65
SLOW_64:
  buffer_store_dword v18, off, s[28:31], s90 sc1
SDONE_65:
  s_mov_b64 exec, -1
  s_branch W2D_59
FINAL_58:
  v_and_b32 v20, 31, v0
  v_lshlrev_b32 v20, 10, v20
  v_lshrrev_b32 v21, 5, v0
  v_lshlrev_b32 v21, 3, v21
  v_add_u32 v20, v20, v21
  s_lshl_b32 s80, s86, 15
  s_and_b32 s81, s5, 7
  s_lshl_b32 s81, s81, 7
  s_add_u32 s80, s80, s81
  s_lshr_b32 s81, s6, 1
  s_lshl_b32 s81, s81, 6
  s_add_u32 s80, s80, s81
  buffer_store_dwordx2 v[2:3], v20, s[32:35], s80 offen offset:0
  buffer_store_dwordx2 v[4:5], v20, s[32:35], s80 offen offset:16
  buffer_store_dwordx2 v[6:7], v20, s[32:35], s80 offen offset:32
  buffer_store_dwordx2 v[8:9], v20, s[32:35], s80 offen offset:48
W2D_59:
  s_add_u32 s3, s3, 1
  s_add_u32 s46, s46, 1
  s_cmp_lt_u32 s3, 2
  s_cbranch_scc1 L_CLAYER
  s_branch L_END
L_HELPER:
  s_sub_u32 s101, s6, 4
  s_lshr_b32 s91, s2, 3
  s_lshl_b32 s91, s91, 2
  s_add_u32 s91, s91, s101
  v_lshlrev_b32 v24, 7, v0
  s_cmp_lg_u32 s101, 3
  s_cbranch_scc1 HCODE_66
  s_getpc_b64 s[94:95]
L_PCREF:
  s_sub_u32 s94, s94, L_PCREF-interleave_layers__sliding_block__dense_activation_squared_relu__prompt_kernel
  s_subb_u32 s95, s95, 0
  s_lshr_b32 s80, s2, 3
  s_mul_i32 s80, s80, ((L_CODE_END-interleave_layers__sliding_block__dense_activation_squared_relu__prompt_kernel)/4096)*128
  v_add_u32 v25, s80, v24
  v_cmp_gt_u32 vcc, (L_CODE_END-interleave_layers__sliding_block__dense_activation_squared_relu__prompt_kernel)/4096, v0
  s_and_saveexec_b64 s[92:93], vcc
  global_load_dword v23, v25, s[94:95]
  s_mov_b64 exec, -1
  s_lshr_b32 s80, s2, 3
  s_mul_i32 s80, s80, 12288
  buffer_load_dword v23, v24, s[12:15], s80 offen
  s_mov_b32 exec_hi, 0
  s_add_u32 s81, s80, 8192
  buffer_load_dword v23, v24, s[12:15], s81 offen
  s_mov_b32 exec_hi, -1
  s_add_u32 s80, s80, 393216
  buffer_load_dword v23, v24, s[12:15], s80 offen
  s_mov_b32 exec_hi, 0
  s_add_u32 s81, s80, 8192
  buffer_load_dword v23, v24, s[12:15], s81 offen
  s_mov_b32 exec_hi, -1
  s_add_u32 s80, s80, 393216
  buffer_load_dword v23, v24, s[12:15], s80 offen
  s_mov_b32 exec_hi, 0
  s_add_u32 s81, s80, 8192
  buffer_load_dword v23, v24, s[12:15], s81 offen
  s_mov_b32 exec_hi, -1
  s_add_u32 s80, s80, 393216
  buffer_load_dword v23, v24, s[12:15], s80 offen
  s_mov_b32 exec_hi, 0
  s_add_u32 s81, s80, 8192
  buffer_load_dword v23, v24, s[12:15], s81 offen
  s_mov_b32 exec_hi, -1
  s_add_u32 s80, s80, 393216
HCODE_66:
  v_lshrrev_b32 v2, 2, v0
  v_mul_u32_u24 v2, 3072, v2
  v_and_b32 v12, 3, v0
  v_lshlrev_b32 v12, 4, v12
  v_add_u32 v2, v2, v12
  s_add_u32 s88, s101, 1
  s_lshl_b32 s88, s88, 10
  s_cmp_eq_u32 s101, 2
  s_cselect_b32 s88, 0, s88
  s_lshl_b32 s89, s5, 6
  s_add_u32 s88, s88, s89
  s_lshl_b32 s89, s101, 15
  s_cmp_ge_u32 s101, 2
  s_cbranch_scc1 HW0_67
  s_mov_b32 s98, 16
DMA_68:
  s_mov_b32 m0, s89
  s_add_u32 s89, s89, 1024
  buffer_load_dwordx4 v2, s[12:15], s88 offen  lds
  s_add_u32 s88, s88, 49152
  s_sub_u32 s98, s98, 1
  s_cmp_lg_u32 s98, 0
  s_cbranch_scc1 DMA_68
HW0_67:
  v_lshrrev_b32 v3, 3, v0
  v_lshlrev_b32 v3, 10, v3
  v_lshrrev_b32 v12, 4, v0
  v_and_b32 v12, 1, v12
  v_lshlrev_b32 v12, 2, v12
  v_and_b32 v13, 7, v0
  v_xor_b32 v12, v12, v13
  v_lshlrev_b32 v12, 4, v12
  v_add_u32 v3, v3, v12
  v_add_u32 v12, 0, v0
  v_mul_u32_u24 v13, 4682, v12
  v_lshrrev_b32 v13, 16, v13
  v_mul_u32_u24 v14, 14, v13
  v_sub_u32 v14, v12, v14
  v_mul_u32_u24 v13, 3584, v13
  v_lshlrev_b32 v14, 4, v14
  v_add_u32 v4, v13, v14
  v_add_u32 v12, 64, v0
  v_mul_u32_u24 v13, 4682, v12
  v_lshrrev_b32 v13, 16, v13
  v_mul_u32_u24 v14, 14, v13
  v_sub_u32 v14, v12, v14
  v_mul_u32_u24 v13, 3584, v13
  v_lshlrev_b32 v14, 4, v14
  v_add_u32 v5, v13, v14
  v_add_u32 v12, 128, v0
  v_mul_u32_u24 v13, 4682, v12
  v_lshrrev_b32 v13, 16, v13
  v_mul_u32_u24 v14, 14, v13
  v_sub_u32 v14, v12, v14
  v_mul_u32_u24 v13, 3584, v13
  v_lshlrev_b32 v14, 4, v14
  v_add_u32 v6, v13, v14
  v_add_u32 v12, 192, v0
  v_mul_u32_u24 v13, 4682, v12
  v_lshrrev_b32 v13, 16, v13
  v_mul_u32_u24 v14, 14, v13
  v_sub_u32 v14, v12, v14
  v_mul_u32_u24 v13, 3584, v13
  v_lshlrev_b32 v14, 4, v14
  v_add_u32 v7, v13, v14
  v_add_u32 v12, 256, v0
  v_mul_u32_u24 v13, 4682, v12
  v_lshrrev_b32 v13, 16, v13
  v_mul_u32_u24 v14, 14, v13
  v_sub_u32 v14, v12, v14
  v_mul_u32_u24 v13, 3584, v13
  v_lshlrev_b32 v14, 4, v14
  v_add_u32 v8, v13, v14
  v_add_u32 v12, 320, v0
  v_mul_u32_u24 v13, 4682, v12
  v_lshrrev_b32 v13, 16, v13
  v_mul_u32_u24 v14, 14, v13
  v_sub_u32 v14, v12, v14
  v_mul_u32_u24 v13, 3584, v13
  v_lshlrev_b32 v14, 4, v14
  v_add_u32 v9, v13, v14
  v_add_u32 v12, 384, v0
  v_mul_u32_u24 v13, 4682, v12
  v_lshrrev_b32 v13, 16, v13
  v_mul_u32_u24 v14, 14, v13
  v_sub_u32 v14, v12, v14
  v_mul_u32_u24 v13, 3584, v13
  v_lshlrev_b32 v14, 4, v14
  v_add_u32 v22, v13, v14
  s_cmp_eq_u32 s101, 3
  s_cbranch_scc1 H3Q_70
  s_cmp_eq_u32 s101, 2
  s_cbranch_scc1 H2Q_69
  v_and_b32 v16, 15, v0
  v_lshrrev_b32 v16, 2, v16
  v_lshlrev_b32 v16, 6, v16
  v_lshrrev_b32 v17, 4, v0
  v_and_b32 v17, 1, v17
  v_lshlrev_b32 v17, 5, v17
  v_add_u32 v16, v16, v17
  v_and_b32 v17, 3, v0
  v_lshlrev_b32 v17, 3, v17
  v_add_u32 v16, v16, v17
  v_lshrrev_b32 v17, 5, v0
  v_lshlrev_b32 v17, 9, v17
  v_add_u32 v16, v16, v17
  s_lshl_b32 s81, s101, 15
  v_add_u32 v12, s81, v16
  v_mov_b32 v48, s100
  v_mov_b32 v49, s100
  v_mov_b32 v50, s100
  v_mov_b32 v51, s100
  v_mov_b32 v32, 0
  v_mov_b32 v33, 0
  v_mov_b32 v34, 0
  v_mov_b32 v35, 0
  v_mov_b32 v36, 0
  v_mov_b32 v37, 0
  v_mov_b32 v38, 0
  v_mov_b32 v39, 0
  v_mov_b32 v40, 0
  v_mov_b32 v41, 0
  v_mov_b32 v42, 0
  v_mov_b32 v43, 0
  v_mov_b32 v44, 0
  v_mov_b32 v45, 0
  v_mov_b32 v46, 0
  v_mov_b32 v47, 0
  s_waitcnt vmcnt(8)
  s_barrier
  s_mov_b32 s98, 8
DMA_72:
  s_mov_b32 m0, s89
  s_add_u32 s89, s89, 1024
  buffer_load_dwordx4 v2, s[12:15], s88 offen  lds
  s_add_u32 s88, s88, 49152
  s_sub_u32 s98, s98, 1
  s_cmp_lg_u32 s98, 0
  s_cbranch_scc1 DMA_72
  ds_read_b64_tr_b16 v[52:53], v12 offset:0
  ds_read_b64_tr_b16 v[54:55], v12 offset:256
  ds_read_b64_tr_b16 v[56:57], v12 offset:1024
  ds_read_b64_tr_b16 v[58:59], v12 offset:1280
  ds_read_b64_tr_b16 v[60:61], v12 offset:2048
  ds_read_b64_tr_b16 v[62:63], v12 offset:2304
  ds_read_b64_tr_b16 v[64:65], v12 offset:3072
  ds_read_b64_tr_b16 v[66:67], v12 offset:3328
  s_waitcnt lgkmcnt(6)
  v_mfma_f32_32x32x16_bf16 v[32:47], v[48:51], v[52:55], v[32:47]
  s_waitcnt lgkmcnt(4)
  v_mfma_f32_32x32x16_bf16 v[32:47], v[48:51], v[56:59], v[32:47]
  s_waitcnt lgkmcnt(2)
  v_mfma_f32_32x32x16_bf16 v[32:47], v[48:51], v[60:63], v[32:47]
  s_waitcnt lgkmcnt(0)
  v_mfma_f32_32x32x16_bf16 v[32:47], v[48:51], v[64:67], v[32:47]
  ds_read_b64_tr_b16 v[52:53], v12 offset:4096
  ds_read_b64_tr_b16 v[54:55], v12 offset:4352
  ds_read_b64_tr_b16 v[56:57], v12 offset:5120
  ds_read_b64_tr_b16 v[58:59], v12 offset:5376
  ds_read_b64_tr_b16 v[60:61], v12 offset:6144
  ds_read_b64_tr_b16 v[62:63], v12 offset:6400
  ds_read_b64_tr_b16 v[64:65], v12 offset:7168
  ds_read_b64_tr_b16 v[66:67], v12 offset:7424
  s_waitcnt lgkmcnt(6)
  v_mfma_f32_32x32x16_bf16 v[32:47], v[48:51], v[52:55], v[32:47]
  s_waitcnt lgkmcnt(4)
  v_mfma_f32_32x32x16_bf16 v[32:47], v[48:51], v[56:59], v[32:47]
  s_waitcnt lgkmcnt(2)
  v_mfma_f32_32x32x16_bf16 v[32:47], v[48:51], v[60:63], v[32:47]
  s_waitcnt lgkmcnt(0)
  v_mfma_f32_32x32x16_bf16 v[32:47], v[48:51], v[64:67], v[32:47]
  s_waitcnt vmcnt(8)
  s_barrier
  s_mov_b32 s98, 8
DMA_73:
  s_mov_b32 m0, s89
  s_add_u32 s89, s89, 1024
  buffer_load_dwordx4 v2, s[12:15], s88 offen  lds
  s_add_u32 s88, s88, 49152
  s_sub_u32 s98, s98, 1
  s_cmp_lg_u32 s98, 0
  s_cbranch_scc1 DMA_73
  ds_read_b64_tr_b16 v[52:53], v12 offset:8192
  ds_read_b64_tr_b16 v[54:55], v12 offset:8448
  ds_read_b64_tr_b16 v[56:57], v12 offset:9216
  ds_read_b64_tr_b16 v[58:59], v12 offset:9472
  ds_read_b64_tr_b16 v[60:61], v12 offset:10240
  ds_read_b64_tr_b16 v[62:63], v12 offset:10496
  ds_read_b64_tr_b16 v[64:65], v12 offset:11264
  ds_read_b64_tr_b16 v[66:67], v12 offset:11520
  s_waitcnt lgkmcnt(6)
  v_mfma_f32_32x32x16_bf16 v[32:47], v[48:51], v[52:55], v[32:47]
  s_waitcnt lgkmcnt(4)
  v_mfma_f32_32x32x16_bf16 v[32:47], v[48:51], v[56:59], v[32:47]
  s_waitcnt lgkmcnt(2)
  v_mfma_f32_32x32x16_bf16 v[32:47], v[48:51], v[60:63], v[32:47]
  s_waitcnt lgkmcnt(0)
  v_mfma_f32_32x32x16_bf16 v[32:47], v[48:51], v[64:67], v[32:47]
  ds_read_b64_tr_b16 v[52:53], v12 offset:12288
  ds_read_b64_tr_b16 v[54:55], v12 offset:12544
  ds_read_b64_tr_b16 v[56:57], v12 offset:13312
  ds_read_b64_tr_b16 v[58:59], v12 offset:13568
  ds_read_b64_tr_b16 v[60:61], v12 offset:14336
  ds_read_b64_tr_b16 v[62:63], v12 offset:14592
  ds_read_b64_tr_b16 v[64:65], v12 offset:15360
  ds_read_b64_tr_b16 v[66:67], v12 offset:15616
  s_waitcnt lgkmcnt(6)
  v_mfma_f32_32x32x16_bf16 v[32:47], v[48:51], v[52:55], v[32:47]
  s_waitcnt lgkmcnt(4)
  v_mfma_f32_32x32x16_bf16 v[32:47], v[48:51], v[56:59], v[32:47]
  s_waitcnt lgkmcnt(2)
  v_mfma_f32_32x32x16_bf16 v[32:47], v[48:51], v[60:63], v[32:47]
  s_waitcnt lgkmcnt(0)
  v_mfma_f32_32x32x16_bf16 v[32:47], v[48:51], v[64:67], v[32:47]
  s_waitcnt vmcnt(8)
  s_barrier
  ds_read_b64_tr_b16 v[52:53], v12 offset:16384
  ds_read_b64_tr_b16 v[54:55], v12 offset:16640
  ds_read_b64_tr_b16 v[56:57], v12 offset:17408
  ds_read_b64_tr_b16 v[58:59], v12 offset:17664
  ds_read_b64_tr_b16 v[60:61], v12 offset:18432
  ds_read_b64_tr_b16 v[62:63], v12 offset:18688
  ds_read_b64_tr_b16 v[64:65], v12 offset:19456
  ds_read_b64_tr_b16 v[66:67], v12 offset:19712
  s_waitcnt lgkmcnt(6)
  v_mfma_f32_32x32x16_bf16 v[32:47], v[48:51], v[52:55], v[32:47]
  s_waitcnt lgkmcnt(4)
  v_mfma_f32_32x32x16_bf16 v[32:47], v[48:51], v[56:59], v[32:47]
  s_waitcnt lgkmcnt(2)
  v_mfma_f32_32x32x16_bf16 v[32:47], v[48:51], v[60:63], v[32:47]
  s_waitcnt lgkmcnt(0)
  v_mfma_f32_32x32x16_bf16 v[32:47], v[48:51], v[64:67], v[32:47]
  ds_read_b64_tr_b16 v[52:53], v12 offset:20480
  ds_read_b64_tr_b16 v[54:55], v12 offset:20736
  ds_read_b64_tr_b16 v[56:57], v12 offset:21504
  ds_read_b64_tr_b16 v[58:59], v12 offset:21760
  ds_read_b64_tr_b16 v[60:61], v12 offset:22528
  ds_read_b64_tr_b16 v[62:63], v12 offset:22784
  ds_read_b64_tr_b16 v[64:65], v12 offset:23552
  ds_read_b64_tr_b16 v[66:67], v12 offset:23808
  s_waitcnt lgkmcnt(6)
  v_mfma_f32_32x32x16_bf16 v[32:47], v[48:51], v[52:55], v[32:47]
  s_waitcnt lgkmcnt(4)
  v_mfma_f32_32x32x16_bf16 v[32:47], v[48:51], v[56:59], v[32:47]
  s_waitcnt lgkmcnt(2)
  v_mfma_f32_32x32x16_bf16 v[32:47], v[48:51], v[60:63], v[32:47]
  s_waitcnt lgkmcnt(0)
  v_mfma_f32_32x32x16_bf16 v[32:47], v[48:51], v[64:67], v[32:47]
  s_waitcnt vmcnt(0)
  s_barrier
  ds_read_b64_tr_b16 v[52:53], v12 offset:24576
  ds_read_b64_tr_b16 v[54:55], v12 offset:24832
  ds_read_b64_tr_b16 v[56:57], v12 offset:25600
  ds_read_b64_tr_b16 v[58:59], v12 offset:25856
  ds_read_b64_tr_b16 v[60:61], v12 offset:26624
  ds_read_b64_tr_b16 v[62:63], v12 offset:26880
  ds_read_b64_tr_b16 v[64:65], v12 offset:27648
  ds_read_b64_tr_b16 v[66:67], v12 offset:27904
  s_waitcnt lgkmcnt(6)
  v_mfma_f32_32x32x16_bf16 v[32:47], v[48:51], v[52:55], v[32:47]
  s_waitcnt lgkmcnt(4)
  v_mfma_f32_32x32x16_bf16 v[32:47], v[48:51], v[56:59], v[32:47]
  s_waitcnt lgkmcnt(2)
  v_mfma_f32_32x32x16_bf16 v[32:47], v[48:51], v[60:63], v[32:47]
  s_waitcnt lgkmcnt(0)
  v_mfma_f32_32x32x16_bf16 v[32:47], v[48:51], v[64:67], v[32:47]
  ds_read_b64_tr_b16 v[52:53], v12 offset:28672
  ds_read_b64_tr_b16 v[54:55], v12 offset:28928
  ds_read_b64_tr_b16 v[56:57], v12 offset:29696
  ds_read_b64_tr_b16 v[58:59], v12 offset:29952
  ds_read_b64_tr_b16 v[60:61], v12 offset:30720
  ds_read_b64_tr_b16 v[62:63], v12 offset:30976
  ds_read_b64_tr_b16 v[64:65], v12 offset:31744
  ds_read_b64_tr_b16 v[66:67], v12 offset:32000
  s_waitcnt lgkmcnt(6)
  v_mfma_f32_32x32x16_bf16 v[32:47], v[48:51], v[52:55], v[32:47]
  s_waitcnt lgkmcnt(4)
  v_mfma_f32_32x32x16_bf16 v[32:47], v[48:51], v[56:59], v[32:47]
  s_waitcnt lgkmcnt(2)
  v_mfma_f32_32x32x16_bf16 v[32:47], v[48:51], v[60:63], v[32:47]
  s_waitcnt lgkmcnt(0)
  v_mfma_f32_32x32x16_bf16 v[32:47], v[48:51], v[64:67], v[32:47]
  s_nop 7
  s_nop 3
  v_sub_f32 v16, 0, v32
  v_cvt_pk_bf16_f32 v17, v16, v16
  v_lshlrev_b32 v18, 16, v17
  v_sub_f32 v18, v16, v18
  v_cvt_pk_bf16_f32 v17, v16, v18
  v_and_b32 v19, 31, v0
  v_lshlrev_b32 v19, 2, v19
  s_lshl_b32 s81, s101, 7
  s_add_u32 s81, s81, 160256
  v_add_u32 v19, s81, v19
  ds_write_b32 v19, v17
  s_waitcnt lgkmcnt(0)
  s_barrier
  s_barrier
  s_branch HQ0E_71
H2Q_69:
  s_barrier
  s_barrier
  s_mov_b32 s98, 16
DMA_74:
  s_mov_b32 m0, s89
  s_add_u32 s89, s89, 1024
  buffer_load_dwordx4 v2, s[12:15], s88 offen  lds
  s_add_u32 s88, s88, 49152
  s_sub_u32 s98, s98, 1
  s_cmp_lg_u32 s98, 0
  s_cbranch_scc1 DMA_74
  s_barrier
  s_mov_b32 s98, 16
DMA_75:
  s_mov_b32 m0, s89
  s_add_u32 s89, s89, 1024
  buffer_load_dwordx4 v2, s[12:15], s88 offen  lds
  s_add_u32 s88, s88, 49152
  s_sub_u32 s98, s98, 1
  s_cmp_lg_u32 s98, 0
  s_cbranch_scc1 DMA_75
  s_barrier
  v_and_b32 v16, 15, v0
  v_lshrrev_b32 v16, 2, v16
  v_lshlrev_b32 v16, 6, v16
  v_lshrrev_b32 v17, 4, v0
  v_and_b32 v17, 1, v17
  v_lshlrev_b32 v17, 5, v17
  v_add_u32 v16, v16, v17
  v_and_b32 v17, 3, v0
  v_lshlrev_b32 v17, 3, v17
  v_add_u32 v16, v16, v17
  v_lshrrev_b32 v17, 5, v0
  v_lshlrev_b32 v17, 9, v17
  v_add_u32 v16, v16, v17
  s_lshl_b32 s81, s101, 15
  v_add_u32 v12, s81, v16
  v_mov_b32 v48, s100
  v_mov_b32 v49, s100
  v_mov_b32 v50, s100
  v_mov_b32 v51, s100
  v_mov_b32 v32, 0
  v_mov_b32 v33, 0
  v_mov_b32 v34, 0
  v_mov_b32 v35, 0
  v_mov_b32 v36, 0
  v_mov_b32 v37, 0
  v_mov_b32 v38, 0
  v_mov_b32 v39, 0
  v_mov_b32 v40, 0
  v_mov_b32 v41, 0
  v_mov_b32 v42, 0
  v_mov_b32 v43, 0
  v_mov_b32 v44, 0
  v_mov_b32 v45, 0
  v_mov_b32 v46, 0
  v_mov_b32 v47, 0
  s_waitcnt vmcnt(24)
  ds_read_b64_tr_b16 v[52:53], v12 offset:0
  ds_read_b64_tr_b16 v[54:55], v12 offset:256
  ds_read_b64_tr_b16 v[56:57], v12 offset:1024
  ds_read_b64_tr_b16 v[58:59], v12 offset:1280
  ds_read_b64_tr_b16 v[60:61], v12 offset:2048
  ds_read_b64_tr_b16 v[62:63], v12 offset:2304
  ds_read_b64_tr_b16 v[64:65], v12 offset:3072
  ds_read_b64_tr_b16 v[66:67], v12 offset:3328
  s_waitcnt lgkmcnt(6)
  v_mfma_f32_32x32x16_bf16 v[32:47], v[48:51], v[52:55], v[32:47]
  s_waitcnt lgkmcnt(4)
  v_mfma_f32_32x32x16_bf16 v[32:47], v[48:51], v[56:59], v[32:47]
  s_waitcnt lgkmcnt(2)
  v_mfma_f32_32x32x16_bf16 v[32:47], v[48:51], v[60:63], v[32:47]
  s_waitcnt lgkmcnt(0)
  v_mfma_f32_32x32x16_bf16 v[32:47], v[48:51], v[64:67], v[32:47]
  ds_read_b64_tr_b16 v[52:53], v12 offset:4096
  ds_read_b64_tr_b16 v[54:55], v12 offset:4352
  ds_read_b64_tr_b16 v[56:57], v12 offset:5120
  ds_read_b64_tr_b16 v[58:59], v12 offset:5376
  ds_read_b64_tr_b16 v[60:61], v12 offset:6144
  ds_read_b64_tr_b16 v[62:63], v12 offset:6400
  ds_read_b64_tr_b16 v[64:65], v12 offset:7168
  ds_read_b64_tr_b16 v[66:67], v12 offset:7424
  s_waitcnt lgkmcnt(6)
  v_mfma_f32_32x32x16_bf16 v[32:47], v[48:51], v[52:55], v[32:47]
  s_waitcnt lgkmcnt(4)
  v_mfma_f32_32x32x16_bf16 v[32:47], v[48:51], v[56:59], v[32:47]
  s_waitcnt lgkmcnt(2)
  v_mfma_f32_32x32x16_bf16 v[32:47], v[48:51], v[60:63], v[32:47]
  s_waitcnt lgkmcnt(0)
  v_mfma_f32_32x32x16_bf16 v[32:47], v[48:51], v[64:67], v[32:47]
  s_waitcnt vmcnt(16)
  ds_read_b64_tr_b16 v[52:53], v12 offset:8192
  ds_read_b64_tr_b16 v[54:55], v12 offset:8448
  ds_read_b64_tr_b16 v[56:57], v12 offset:9216
  ds_read_b64_tr_b16 v[58:59], v12 offset:9472
  ds_read_b64_tr_b16 v[60:61], v12 offset:10240
  ds_read_b64_tr_b16 v[62:63], v12 offset:10496
  ds_read_b64_tr_b16 v[64:65], v12 offset:11264
  ds_read_b64_tr_b16 v[66:67], v12 offset:11520
  s_waitcnt lgkmcnt(6)
  v_mfma_f32_32x32x16_bf16 v[32:47], v[48:51], v[52:55], v[32:47]
  s_waitcnt lgkmcnt(4)
  v_mfma_f32_32x32x16_bf16 v[32:47], v[48:51], v[56:59], v[32:47]
  s_waitcnt lgkmcnt(2)
  v_mfma_f32_32x32x16_bf16 v[32:47], v[48:51], v[60:63], v[32:47]
  s_waitcnt lgkmcnt(0)
  v_mfma_f32_32x32x16_bf16 v[32:47], v[48:51], v[64:67], v[32:47]
  ds_read_b64_tr_b16 v[52:53], v12 offset:12288
  ds_read_b64_tr_b16 v[54:55], v12 offset:12544
  ds_read_b64_tr_b16 v[56:57], v12 offset:13312
  ds_read_b64_tr_b16 v[58:59], v12 offset:13568
  ds_read_b64_tr_b16 v[60:61], v12 offset:14336
  ds_read_b64_tr_b16 v[62:63], v12 offset:14592
  ds_read_b64_tr_b16 v[64:65], v12 offset:15360
  ds_read_b64_tr_b16 v[66:67], v12 offset:15616
  s_waitcnt lgkmcnt(6)
  v_mfma_f32_32x32x16_bf16 v[32:47], v[48:51], v[52:55], v[32:47]
  s_waitcnt lgkmcnt(4)
  v_mfma_f32_32x32x16_bf16 v[32:47], v[48:51], v[56:59], v[32:47]
  s_waitcnt lgkmcnt(2)
  v_mfma_f32_32x32x16_bf16 v[32:47], v[48:51], v[60:63], v[32:47]
  s_waitcnt lgkmcnt(0)
  v_mfma_f32_32x32x16_bf16 v[32:47], v[48:51], v[64:67], v[32:47]
  s_waitcnt vmcnt(8)
  ds_read_b64_tr_b16 v[52:53], v12 offset:16384
  ds_read_b64_tr_b16 v[54:55], v12 offset:16640
  ds_read_b64_tr_b16 v[56:57], v12 offset:17408
  ds_read_b64_tr_b16 v[58:59], v12 offset:17664
  ds_read_b64_tr_b16 v[60:61], v12 offset:18432
  ds_read_b64_tr_b16 v[62:63], v12 offset:18688
  ds_read_b64_tr_b16 v[64:65], v12 offset:19456
  ds_read_b64_tr_b16 v[66:67], v12 offset:19712
  s_waitcnt lgkmcnt(6)
  v_mfma_f32_32x32x16_bf16 v[32:47], v[48:51], v[52:55], v[32:47]
  s_waitcnt lgkmcnt(4)
  v_mfma_f32_32x32x16_bf16 v[32:47], v[48:51], v[56:59], v[32:47]
  s_waitcnt lgkmcnt(2)
  v_mfma_f32_32x32x16_bf16 v[32:47], v[48:51], v[60:63], v[32:47]
  s_waitcnt lgkmcnt(0)
  v_mfma_f32_32x32x16_bf16 v[32:47], v[48:51], v[64:67], v[32:47]
  ds_read_b64_tr_b16 v[52:53], v12 offset:20480
  ds_read_b64_tr_b16 v[54:55], v12 offset:20736
  ds_read_b64_tr_b16 v[56:57], v12 offset:21504
  ds_read_b64_tr_b16 v[58:59], v12 offset:21760
  ds_read_b64_tr_b16 v[60:61], v12 offset:22528
  ds_read_b64_tr_b16 v[62:63], v12 offset:22784
  ds_read_b64_tr_b16 v[64:65], v12 offset:23552
  ds_read_b64_tr_b16 v[66:67], v12 offset:23808
  s_waitcnt lgkmcnt(6)
  v_mfma_f32_32x32x16_bf16 v[32:47], v[48:51], v[52:55], v[32:47]
  s_waitcnt lgkmcnt(4)
  v_mfma_f32_32x32x16_bf16 v[32:47], v[48:51], v[56:59], v[32:47]
  s_waitcnt lgkmcnt(2)
  v_mfma_f32_32x32x16_bf16 v[32:47], v[48:51], v[60:63], v[32:47]
  s_waitcnt lgkmcnt(0)
  v_mfma_f32_32x32x16_bf16 v[32:47], v[48:51], v[64:67], v[32:47]
  s_waitcnt vmcnt(0)
  s_barrier
  ds_read_b64_tr_b16 v[52:53], v12 offset:24576
  ds_read_b64_tr_b16 v[54:55], v12 offset:24832
  ds_read_b64_tr_b16 v[56:57], v12 offset:25600
  ds_read_b64_tr_b16 v[58:59], v12 offset:25856
  ds_read_b64_tr_b16 v[60:61], v12 offset:26624
  ds_read_b64_tr_b16 v[62:63], v12 offset:26880
  ds_read_b64_tr_b16 v[64:65], v12 offset:27648
  ds_read_b64_tr_b16 v[66:67], v12 offset:27904
  s_waitcnt lgkmcnt(6)
  v_mfma_f32_32x32x16_bf16 v[32:47], v[48:51], v[52:55], v[32:47]
  s_waitcnt lgkmcnt(4)
  v_mfma_f32_32x32x16_bf16 v[32:47], v[48:51], v[56:59], v[32:47]
  s_waitcnt lgkmcnt(2)
  v_mfma_f32_32x32x16_bf16 v[32:47], v[48:51], v[60:63], v[32:47]
  s_waitcnt lgkmcnt(0)
  v_mfma_f32_32x32x16_bf16 v[32:47], v[48:51], v[64:67], v[32:47]
  ds_read_b64_tr_b16 v[52:53], v12 offset:28672
  ds_read_b64_tr_b16 v[54:55], v12 offset:28928
  ds_read_b64_tr_b16 v[56:57], v12 offset:29696
  ds_read_b64_tr_b16 v[58:59], v12 offset:29952
  ds_read_b64_tr_b16 v[60:61], v12 offset:30720
  ds_read_b64_tr_b16 v[62:63], v12 offset:30976
  ds_read_b64_tr_b16 v[64:65], v12 offset:31744
  ds_read_b64_tr_b16 v[66:67], v12 offset:32000
  s_waitcnt lgkmcnt(6)
  v_mfma_f32_32x32x16_bf16 v[32:47], v[48:51], v[52:55], v[32:47]
  s_waitcnt lgkmcnt(4)
  v_mfma_f32_32x32x16_bf16 v[32:47], v[48:51], v[56:59], v[32:47]
  s_waitcnt lgkmcnt(2)
  v_mfma_f32_32x32x16_bf16 v[32:47], v[48:51], v[60:63], v[32:47]
  s_waitcnt lgkmcnt(0)
  v_mfma_f32_32x32x16_bf16 v[32:47], v[48:51], v[64:67], v[32:47]
  s_nop 7
  s_nop 3
  v_sub_f32 v16, 0, v32
  v_cvt_pk_bf16_f32 v17, v16, v16
  v_lshlrev_b32 v18, 16, v17
  v_sub_f32 v18, v16, v18
  v_cvt_pk_bf16_f32 v17, v16, v18
  v_and_b32 v19, 31, v0
  v_lshlrev_b32 v19, 2, v19
  s_lshl_b32 s81, s101, 7
  s_add_u32 s81, s81, 160256
  v_add_u32 v19, s81, v19
  ds_write_b32 v19, v17
  s_waitcnt lgkmcnt(0)
  s_barrier
  s_branch HQ0E_71
H3Q_70:
  v_mov_b32 v12, 0
  v_mov_b32 v13, 0
  v_mov_b32 v14, 0
  v_mov_b32 v15, 0
  s_lshl_b32 s80, s4, 4
  s_add_u32 s80, s80, s5
  s_lshl_b32 s81, s80, 10
  s_add_u32 s81, s81, 65536
  buffer_store_dwordx4 v[12:15], v1, s[28:31], s81 offen sc1
  s_lshl_b32 s81, s5, 8
  s_add_u32 s81, s81, s47
  s_add_u32 s81, s81, 0
  s_mov_b32 exec_lo, 0xffff
  s_mov_b32 exec_hi, 0
  buffer_store_dwordx4 v[12:15], v1, s[28:31], s81 offen sc1
  s_mov_b64 exec, -1
  v_mov_b32 v16, 0x3f80
  v_mov_b32 v17, 0
  v_mov_b32 v18, 0
  v_mov_b32 v19, 0
  v_lshlrev_b32 v20, 7, v0
  v_add_u32 v20, 159744, v20
  s_mov_b64 exec, 15
  ds_write_b128 v20, v[16:19]
  s_mov_b64 exec, -1
  s_getreg_b32 s82, hwreg(HW_REG_XCC_ID)
  s_and_b32 s82, s82, 15
  s_or_b32 s82, s82, 0x80
  s_mov_b32 s36, s44
  s_and_b32 s37, s45, 0xffff
  s_mov_b32 s38, 256
  s_mov_b32 s39, 0x20000
  v_mov_b32 v16, s82
  s_mov_b32 s93, s80
  s_waitcnt lgkmcnt(0)
  s_barrier
  s_barrier
  s_barrier
  s_waitcnt vmcnt(0)
  s_mov_b64 exec, 1
  buffer_store_byte v16, off, s[36:39], s93 sc1
  s_mov_b64 exec, -1
  s_barrier
  s_barrier
  s_barrier
HQ0E_71:
  s_mul_i32 s80, s101, 24576
  v_add_u32 v12, s80, v1
  ds_read_b128 v[160:163], v12 offset:0
  ds_read_b128 v[164:167], v12 offset:1024
  ds_read_b128 v[168:171], v12 offset:2048
  ds_read_b128 v[172:175], v12 offset:3072
  ds_read_b128 v[176:179], v12 offset:4096
  ds_read_b128 v[180:183], v12 offset:5120
  ds_read_b128 v[184:187], v12 offset:6144
  ds_read_b128 v[188:191], v12 offset:7168
  ds_read_b128 v[192:195], v12 offset:8192
  ds_read_b128 v[196:199], v12 offset:9216
  ds_read_b128 v[200:203], v12 offset:10240
  ds_read_b128 v[204:207], v12 offset:11264
  s_waitcnt lgkmcnt(0)
  ds_read_b128 v[208:211], v12 offset:12288
  ds_read_b128 v[212:215], v12 offset:13312
  ds_read_b128 v[216:219], v12 offset:14336
  ds_read_b128 v[220:223], v12 offset:15360
  ds_read_b128 v[224:227], v12 offset:16384
  ds_read_b128 v[228:231], v12 offset:17408
  ds_read_b128 v[232:235], v12 offset:18432
  ds_read_b128 v[236:239], v12 offset:19456
  ds_read_b128 v[240:243], v12 offset:20480
  ds_read_b128 v[244:247], v12 offset:21504
  ds_read_b128 v[248:251], v12 offset:22528
  ds_read_b128 v[252:255], v12 offset:23552
  s_waitcnt lgkmcnt(0)
  s_branch L_HPOSTQ
L_HLAYER:
  s_mul_i32 s80, s101, 24576
  v_add_u32 v12, s80, v1
  ds_write_b128 v12, v[160:163] offset:0
  ds_write_b128 v12, v[164:167] offset:1024
  ds_write_b128 v12, v[168:171] offset:2048
  ds_write_b128 v12, v[172:175] offset:3072
  ds_write_b128 v12, v[176:179] offset:4096
  ds_write_b128 v12, v[180:183] offset:5120
  ds_write_b128 v12, v[184:187] offset:6144
  ds_write_b128 v12, v[188:191] offset:7168
  ds_write_b128 v12, v[192:195] offset:8192
  ds_write_b128 v12, v[196:199] offset:9216
  ds_write_b128 v12, v[200:203] offset:10240
  ds_write_b128 v12, v[204:207] offset:11264
  ds_write_b128 v12, v[208:211] offset:12288
  ds_write_b128 v12, v[212:215] offset:13312
  ds_write_b128 v12, v[216:219] offset:14336
  ds_write_b128 v12, v[220:223] offset:15360
  ds_write_b128 v12, v[224:227] offset:16384
  ds_write_b128 v12, v[228:231] offset:17408
  ds_write_b128 v12, v[232:235] offset:18432
  ds_write_b128 v12, v[236:239] offset:19456
  ds_write_b128 v12, v[240:243] offset:20480
  ds_write_b128 v12, v[244:247] offset:21504
  ds_write_b128 v12, v[248:251] offset:22528
  ds_write_b128 v12, v[252:255] offset:23552
  s_waitcnt lgkmcnt(0)
  s_barrier
  s_barrier
  s_barrier
  s_barrier
  s_barrier
  s_barrier
L_HPOSTQ:
  s_cmp_lg_u32 s101, 3
  s_cbranch_scc1 HH_76
  s_cmp_eq_u32 s3, 0
  s_cbranch_scc0 HRDY_77
  s_waitcnt lgkmcnt(0)
  s_lshl_b32 s80, s4, 4
  s_add_u32 s81, s80, s5
  v_mov_b32 v12, s81
  v_add_u32 v13, s80, v0
  v_cmp_gt_u32 vcc, 16, v0
  s_nop 1
  v_cndmask_b32 v12, v12, v13, vcc
  s_sub_u32 s82, s81, 16
  s_cmp_ge_u32 s4, 1
  s_cselect_b32 s82, s82, s81
  v_mov_b32 v13, s82
  v_cmp_eq_u32 vcc, 16, v0
  s_nop 1
  v_cndmask_b32 v12, v12, v13, vcc
  s_sub_u32 s82, s81, 32
  s_cmp_ge_u32 s4, 2
  s_cselect_b32 s82, s82, s81
  v_mov_b32 v13, s82
  v_cmp_eq_u32 vcc, 17, v0
  s_nop 1
  v_cndmask_b32 v12, v12, v13, vcc
  s_mov_b32 s36, s44
  s_and_b32 s37, s45, 0xffff
  s_mov_b32 s38, 256
  s_mov_b32 s39, 0x20000
  s_mov_b32 s99, 0
RDY_78:
  buffer_load_ubyte v13, v12, s[36:39], 0 offen sc1
  s_add_u32 s99, s99, 1
  s_cmp_gt_u32 s99, 100000
  s_cbranch_scc1 L_BAIL
  s_waitcnt vmcnt(0)
  v_cmp_gt_u32 vcc, 0x80, v13
  s_cbranch_vccnz RDY_78
  s_getreg_b32 s82, hwreg(HW_REG_XCC_ID)
  s_and_b32 s82, s82, 15
  s_or_b32 s82, s82, 0x80
  v_cmp_eq_u32 vcc, s82, v13
  s_nop 4
  s_and_b32 s80, vcc_lo, 0xffff
  s_cmp_eq_u32 s80, 0xffff
  s_cselect_b32 s80, 1, 0
  v_mov_b32 v13, s80
  v_mov_b32 v14, 161792
  ds_write_b32 v14, v13
  s_waitcnt lgkmcnt(0)
HRDY_77:
  s_waitcnt lgkmcnt(0)
  s_cmp_ge_u32 s4, 2
  s_cbranch_scc1 HALOZ_80
  v_mov_b32 v12, 0
  v_mov_b32 v13, 0
  v_mov_b32 v14, 0
  v_mov_b32 v15, 0
  s_cmp_eq_u32 s4, 0
  s_cselect_b32 s83, 8, 4
  v_add_u32 v16, 98304, v1
ZF_81:
  ds_write_b128 v16, v[12:15] offset:0
  ds_write_b128 v16, v[12:15] offset:12288
  ds_write_b128 v16, v[12:15] offset:24576
  ds_write_b128 v16, v[12:15] offset:36864
  v_add_u32 v16, 1024, v16
  s_sub_u32 s83, s83, 1
  s_cmp_lg_u32 s83, 0
  s_cbranch_scc1 ZF_81
  s_waitcnt lgkmcnt(0)
HALOZ_80:
  s_cmp_eq_u32 s4, 0
  s_cbranch_scc1 HALOD_79
  v_lshrrev_b32 v12, 2, v0
  v_and_b32 v12, 1, v12
  s_cmp_ge_u32 s4, 2
  s_cselect_b32 s80, 1, 0
  v_and_b32 v12, s80, v12
  s_sub_u32 s81, s4, 1
  v_sub_u32 v12, s81, v12
  v_lshlrev_b32 v12, 4, v12
  v_add_u32 v12, s5, v12
  v_lshlrev_b32 v12, 2, v12
  v_and_b32 v13, 3, v0
  v_add_u32 v12, v12, v13
  v_lshlrev_b32 v12, 8, v12
  s_mov_b32 s80, 65536
  s_mov_b32 s99, 0
POLL_82:
  buffer_load_dword v13, v12, s[28:31], s80 offen sc1
  s_add_u32 s99, s99, 1
  s_cmp_gt_u32 s99, 100000
  s_cbranch_scc1 L_BAIL
  s_waitcnt vmcnt(0)
  v_cmp_gt_u32 vcc, s46, v13
  s_cbranch_vccnz POLL_82
POLLOK_83:
  s_cmp_ge_u32 s4, 2
  s_cselect_b32 s83, 0, 4
  s_lshl_b32 s80, s4, 2
  s_add_u32 s80, s80, s83
  s_sub_u32 s80, s80, 8
  s_lshl_b32 s80, s80, 16
  s_lshl_b32 s81, s5, 12
  s_add_u32 s80, s80, s81
  s_lshl_b32 s81, s3, 22
  s_add_u32 s80, s80, s81
  s_add_u32 s80, s80, 14680064
  s_lshl_b32 s81, s83, 10
HALO_84:
  s_add_u32 m0, s81, 98304
  s_add_u32 s82, s80, 0
  buffer_load_dwordx4 v1, s[28:31], s82 offen sc1 lds
  s_add_u32 m0, s81, 122880
  s_add_u32 s82, s80, 1024
  buffer_load_dwordx4 v1, s[28:31], s82 offen sc1 lds
  s_add_u32 m0, s81, 110592
  s_add_u32 s82, s80, 2048
  buffer_load_dwordx4 v1, s[28:31], s82 offen sc1 lds
  s_add_u32 m0, s81, 135168
  s_add_u32 s82, s80, 3072
  buffer_load_dwordx4 v1, s[28:31], s82 offen sc1 lds
  s_add_u32 s80, s80, 65536
  s_add_u32 s81, s81, 1024
  s_add_u32 s83, s83, 1
  s_cmp_lt_u32 s83, 8
  s_cbranch_scc1 HALO_84
  s_waitcnt vmcnt(0)
HALOD_79:
HH_76:
  s_waitcnt lgkmcnt(0)
  s_barrier
  s_lshr_b32 s80, s2, 3
  s_mul_i32 s80, s80, 16384
  s_mul_i32 s81, s101, 4096
  s_add_u32 s80, s80, s81
  s_add_u32 s80, s80, 0
  s_mov_b32 exec_lo, 0xffffffff
  s_mov_b32 exec_hi, 0
  buffer_load_dword v23, v24, s[16:19], s80 offen
  s_mov_b64 exec, -1
  s_lshr_b32 s80, s2, 3
  s_mul_i32 s80, s80, 57344
  s_mul_i32 s81, s101, 14336
  s_add_u32 s80, s80, s81
  s_add_u32 s80, s80, 0
  buffer_load_dword v23, v24, s[20:23], s80 offen
  s_add_u32 s80, s80, 8192
  s_mov_b32 exec_hi, 0xffff
  buffer_load_dword v23, v24, s[20:23], s80 offen
  s_mov_b64 exec, -1
  s_waitcnt vmcnt(0)
  s_and_b32 s80, s5, 7
  s_lshl_b32 s80, s80, 7
  s_lshl_b32 s81, s101, 17
  s_add_u32 s80, s80, s81
  s_lshl_b32 s81, s101, 14
  s_mov_b32 s98, 16
DMA_85:
  s_mov_b32 m0, s81
  s_add_u32 s81, s81, 1024
  buffer_load_dwordx4 v3, s[16:19], s80 offen  lds
  s_add_u32 s80, s80, 8192
  s_sub_u32 s98, s98, 1
  s_cmp_lg_u32 s98, 0
  s_cbranch_scc1 DMA_85
  s_mul_i32 s81, s101, 1
  s_mul_i32 s80, s81, 114688
  s_mul_i32 s81, s81, 7168
  s_add_u32 s81, s81, 65536
  s_mul_i32 s82, s5, 224
  s_add_u32 s80, s80, s82
  s_add_u32 s80, s80, 0
  s_add_u32 m0, s81, 0
  s_nop 0
  buffer_load_dwordx4 v4, s[20:23], s80 offen lds
  s_add_u32 m0, s81, 1024
  s_nop 0
  buffer_load_dwordx4 v5, s[20:23], s80 offen lds
  s_add_u32 m0, s81, 2048
  s_nop 0
  buffer_load_dwordx4 v6, s[20:23], s80 offen lds
  s_add_u32 m0, s81, 3072
  s_nop 0
  buffer_load_dwordx4 v7, s[20:23], s80 offen lds
  s_add_u32 m0, s81, 4096
  s_nop 0
  buffer_load_dwordx4 v8, s[20:23], s80 offen lds
  s_add_u32 m0, s81, 5120
  s_nop 0
  buffer_load_dwordx4 v9, s[20:23], s80 offen lds
  s_add_u32 m0, s81, 6144
  s_nop 0
  buffer_load_dwordx4 v22, s[20:23], s80 offen lds
  s_waitcnt vmcnt(0)
  s_barrier
  s_cmp_eq_u32 s3, 0
  s_cbranch_scc0 IL0_86
  s_waitcnt lgkmcnt(0)
  s_mul_i32 s92, s91, 1792
  s_add_u32 s92, s92, 0
  s_add_u32 s0, s24, s92
  s_addc_u32 s1, s25, 0
  s_load_dword s96, s[0:1], 0
  s_load_dword s96, s[0:1], 128
  s_load_dword s96, s[0:1], 256
  s_load_dword s96, s[0:1], 384
  s_load_dword s96, s[0:1], 512
  s_load_dword s96, s[0:1], 640
  s_load_dword s96, s[0:1], 768
  s_load_dword s96, s[0:1], 896
  s_load_dword s96, s[0:1], 1024
  s_load_dword s96, s[0:1], 1152
  s_load_dword s96, s[0:1], 1280
  s_load_dword s96, s[0:1], 1408
  s_load_dword s96, s[0:1], 1536
  s_load_dword s96, s[0:1], 1664
IL0_86:
  s_mul_i32 s81, s101, 2
  s_mul_i32 s80, s81, 114688
  s_mul_i32 s81, s81, 7168
  s_add_u32 s81, s81, 98304
  s_mul_i32 s82, s5, 224
  s_add_u32 s80, s80, s82
  s_add_u32 s80, s80, 458752
  s_add_u32 m0, s81, 0
  s_nop 0
  buffer_load_dwordx4 v4, s[20:23], s80 offen lds
  s_add_u32 m0, s81, 1024
  s_nop 0
  buffer_load_dwordx4 v5, s[20:23], s80 offen lds
  s_add_u32 m0, s81, 2048
  s_nop 0
  buffer_load_dwordx4 v6, s[20:23], s80 offen lds
  s_add_u32 m0, s81, 3072
  s_nop 0
  buffer_load_dwordx4 v7, s[20:23], s80 offen lds
  s_add_u32 m0, s81, 4096
  s_nop 0
  buffer_load_dwordx4 v8, s[20:23], s80 offen lds
  s_add_u32 m0, s81, 5120
  s_nop 0
  buffer_load_dwordx4 v9, s[20:23], s80 offen lds
  s_add_u32 m0, s81, 6144
  s_nop 0
  buffer_load_dwordx4 v22, s[20:23], s80 offen lds
  s_add_u32 s80, s80, 114688
  s_add_u32 m0, s81, 7168
  s_nop 0
  buffer_load_dwordx4 v4, s[20:23], s80 offen lds
  s_add_u32 m0, s81, 8192
  s_nop 0
  buffer_load_dwordx4 v5, s[20:23], s80 offen lds
  s_add_u32 m0, s81, 9216
  s_nop 0
  buffer_load_dwordx4 v6, s[20:23], s80 offen lds
  s_add_u32 m0, s81, 10240
  s_nop 0
  buffer_load_dwordx4 v7, s[20:23], s80 offen lds
  s_add_u32 m0, s81, 11264
  s_nop 0
  buffer_load_dwordx4 v8, s[20:23], s80 offen lds
  s_add_u32 m0, s81, 12288
  s_nop 0
  buffer_load_dwordx4 v9, s[20:23], s80 offen lds
  s_add_u32 m0, s81, 13312
  s_nop 0
  buffer_load_dwordx4 v22, s[20:23], s80 offen lds
  s_cmp_eq_u32 s3, 0
  s_cbranch_scc0 IL0_87
  s_waitcnt lgkmcnt(0)
  s_mul_i32 s92, s91, 1792
  s_add_u32 s92, s92, 229376
  s_add_u32 s0, s24, s92
  s_addc_u32 s1, s25, 0
  s_load_dword s96, s[0:1], 0
  s_load_dword s96, s[0:1], 128
  s_load_dword s96, s[0:1], 256
  s_load_dword s96, s[0:1], 384
  s_load_dword s96, s[0:1], 512
  s_load_dword s96, s[0:1], 640
  s_load_dword s96, s[0:1], 768
  s_load_dword s96, s[0:1], 896
  s_load_dword s96, s[0:1], 1024
  s_load_dword s96, s[0:1], 1152
  s_load_dword s96, s[0:1], 1280
  s_load_dword s96, s[0:1], 1408
  s_load_dword s96, s[0:1], 1536
  s_load_dword s96, s[0:1], 1664
IL0_87:
  s_barrier
  s_barrier
  s_cmp_eq_u32 s3, 0
  s_cbranch_scc0 IL0_88
  s_waitcnt lgkmcnt(0)
  s_mul_i32 s92, s91, 1792
  s_add_u32 s92, s92, 458752
  s_add_u32 s0, s24, s92
  s_addc_u32 s1, s25, 0
  s_load_dword s96, s[0:1], 0
  s_load_dword s96, s[0:1], 128
  s_load_dword s96, s[0:1], 256
  s_load_dword s96, s[0:1], 384
  s_load_dword s96, s[0:1], 512
  s_load_dword s96, s[0:1], 640
  s_load_dword s96, s[0:1], 768
  s_load_dword s96, s[0:1], 896
  s_load_dword s96, s[0:1], 1024
  s_load_dword s96, s[0:1], 1152
  s_load_dword s96, s[0:1], 1280
  s_load_dword s96, s[0:1], 1408
  s_load_dword s96, s[0:1], 1536
  s_load_dword s96, s[0:1], 1664
IL0_88:
  s_mul_i32 s81, s101, 1
  s_mul_i32 s80, s81, 114688
  s_mul_i32 s81, s81, 7168
  s_add_u32 s81, s81, 0
  s_mul_i32 s82, s5, 224
  s_add_u32 s80, s80, s82
  s_add_u32 s80, s80, 1376256
  s_add_u32 m0, s81, 0
  s_nop 0
  buffer_load_dwordx4 v4, s[20:23], s80 offen lds
  s_add_u32 m0, s81, 1024
  s_nop 0
  buffer_load_dwordx4 v5, s[20:23], s80 offen lds
  s_add_u32 m0, s81, 2048
  s_nop 0
  buffer_load_dwordx4 v6, s[20:23], s80 offen lds
  s_add_u32 m0, s81, 3072
  s_nop 0
  buffer_load_dwordx4 v7, s[20:23], s80 offen lds
  s_add_u32 m0, s81, 4096
  s_nop 0
  buffer_load_dwordx4 v8, s[20:23], s80 offen lds
  s_add_u32 m0, s81, 5120
  s_nop 0
  buffer_load_dwordx4 v9, s[20:23], s80 offen lds
  s_add_u32 m0, s81, 6144
  s_nop 0
  buffer_load_dwordx4 v22, s[20:23], s80 offen lds
  s_waitcnt vmcnt(0)
  s_barrier
  s_cmp_eq_u32 s3, 0
  s_cbranch_scc0 IL0_89
  s_waitcnt lgkmcnt(0)
  v_lshrrev_b32 v16, 4, v0
  v_and_b32 v17, 1, v16
  v_lshlrev_b32 v17, 2, v17
  v_lshrrev_b32 v16, 1, v16
  v_lshlrev_b32 v16, 4, v16
  v_add_u32 v16, v16, v17
  v_and_b32 v17, 15, v0
  v_lshrrev_b32 v17, 2, v17
  v_add_u32 v16, v16, v17
  v_mul_u32_u24 v16, 224, v16
  v_and_b32 v17, 3, v0
  v_lshlrev_b32 v17, 3, v17
  v_add_u32 v16, v16, v17
  s_mov_b32 s36, s42
  s_and_b32 s37, s43, 0xffff
  s_mov_b32 s38, 3584
  s_mov_b32 s39, 0x20000
  s_mov_b32 s84, s101
  v_mov_b32 v48, s100
  v_mov_b32 v49, s100
  v_mov_b32 v50, s100
  v_mov_b32 v51, s100
CS1_90:
  s_lshl_b32 s80, s84, 5
  v_add_u32 v12, s80, v16
  v_add_u32 v13, 0x10000, v12
  v_add_u32 v14, 0x20000, v12
  s_mul_i32 s81, s5, 224
  s_add_u32 s81, s81, s80
  v_and_b32 v17, 15, v0
  v_lshlrev_b32 v17, 1, v17
  buffer_load_ushort v33, v17, s[36:39], s81 offen
  v_mov_b32 v36, 0
  v_mov_b32 v37, 0
  v_mov_b32 v38, 0
  v_mov_b32 v39, 0
  ds_read_b64_tr_b16 v[52:53], v13 offset:0
  ds_read_b64_tr_b16 v[54:55], v13 offset:1792
  ds_read_b64_tr_b16 v[56:57], v13 offset:7168
  ds_read_b64_tr_b16 v[58:59], v13 offset:8960
  ds_read_b64_tr_b16 v[60:61], v13 offset:14336
  ds_read_b64_tr_b16 v[62:63], v13 offset:16128
  ds_read_b64_tr_b16 v[64:65], v13 offset:21504
  ds_read_b64_tr_b16 v[66:67], v13 offset:23296
  s_waitcnt lgkmcnt(6)
  v_mfma_f32_16x16x32_bf16 v[36:39], v[48:51], v[52:55], v[36:39]
  s_waitcnt lgkmcnt(4)
  v_mfma_f32_16x16x32_bf16 v[36:39], v[48:51], v[56:59], v[36:39]
  s_waitcnt lgkmcnt(2)
  v_mfma_f32_16x16x32_bf16 v[36:39], v[48:51], v[60:63], v[36:39]
  s_waitcnt lgkmcnt(0)
  v_mfma_f32_16x16x32_bf16 v[36:39], v[48:51], v[64:67], v[36:39]
  ds_read_b64_tr_b16 v[52:53], v13 offset:32768
  ds_read_b64_tr_b16 v[54:55], v13 offset:34560
  ds_read_b64_tr_b16 v[56:57], v13 offset:39936
  ds_read_b64_tr_b16 v[58:59], v13 offset:41728
  ds_read_b64_tr_b16 v[60:61], v13 offset:47104
  ds_read_b64_tr_b16 v[62:63], v13 offset:48896
  ds_read_b64_tr_b16 v[64:65], v13 offset:54272
  ds_read_b64_tr_b16 v[66:67], v13 offset:56064
  s_waitcnt lgkmcnt(6)
  v_mfma_f32_16x16x32_bf16 v[36:39], v[48:51], v[52:55], v[36:39]
  s_waitcnt lgkmcnt(4)
  v_mfma_f32_16x16x32_bf16 v[36:39], v[48:51], v[56:59], v[36:39]
  s_waitcnt lgkmcnt(2)
  v_mfma_f32_16x16x32_bf16 v[36:39], v[48:51], v[60:63], v[36:39]
  s_waitcnt lgkmcnt(0)
  v_mfma_f32_16x16x32_bf16 v[36:39], v[48:51], v[64:67], v[36:39]
  ds_read_b64_tr_b16 v[52:53], v13 offset:61440
  ds_read_b64_tr_b16 v[54:55], v13 offset:63232
  ds_read_b64_tr_b16 v[56:57], v14 offset:3072
  ds_read_b64_tr_b16 v[58:59], v14 offset:4864
  ds_read_b64_tr_b16 v[60:61], v14 offset:10240
  ds_read_b64_tr_b16 v[62:63], v14 offset:12032
  ds_read_b64_tr_b16 v[64:65], v14 offset:17408
  ds_read_b64_tr_b16 v[66:67], v14 offset:19200
  s_waitcnt lgkmcnt(6)
  v_mfma_f32_16x16x32_bf16 v[36:39], v[48:51], v[52:55], v[36:39]
  s_waitcnt lgkmcnt(4)
  v_mfma_f32_16x16x32_bf16 v[36:39], v[48:51], v[56:59], v[36:39]
  s_waitcnt lgkmcnt(2)
  v_mfma_f32_16x16x32_bf16 v[36:39], v[48:51], v[60:63], v[36:39]
  s_waitcnt lgkmcnt(0)
  v_mfma_f32_16x16x32_bf16 v[36:39], v[48:51], v[64:67], v[36:39]
  ds_read_b64_tr_b16 v[52:53], v12 offset:0
  ds_read_b64_tr_b16 v[54:55], v12 offset:1792
  ds_read_b64_tr_b16 v[56:57], v12 offset:7168
  ds_read_b64_tr_b16 v[58:59], v12 offset:8960
  ds_read_b64_tr_b16 v[60:61], v12 offset:14336
  ds_read_b64_tr_b16 v[62:63], v12 offset:16128
  ds_read_b64_tr_b16 v[64:65], v12 offset:21504
  ds_read_b64_tr_b16 v[66:67], v12 offset:23296
  s_waitcnt lgkmcnt(6)
  v_mfma_f32_16x16x32_bf16 v[36:39], v[48:51], v[52:55], v[36:39]
  s_waitcnt lgkmcnt(4)
  v_mfma_f32_16x16x32_bf16 v[36:39], v[48:51], v[56:59], v[36:39]
  s_waitcnt lgkmcnt(2)
  v_mfma_f32_16x16x32_bf16 v[36:39], v[48:51], v[60:63], v[36:39]
  s_waitcnt lgkmcnt(0)
  v_mfma_f32_16x16x32_bf16 v[36:39], v[48:51], v[64:67], v[36:39]
  s_nop 7
  v_sub_f32 v18, 0, v36
  v_cvt_pk_bf16_f32 v19, v18, v18
  v_lshlrev_b32 v20, 16, v19
  v_sub_f32 v20, v18, v20
  v_cvt_pk_bf16_f32 v32, v18, v20
  v_lshlrev_b32 v17, 2, v17
  s_lshl_b32 s80, s84, 7
  s_add_u32 s80, s80, 160768
  v_add_u32 v17, s80, v17
  s_waitcnt vmcnt(0)
  ds_write_b64 v17, v[32:33]
  s_add_u32 s84, s84, 4
  s_cmp_lt_u32 s84, 7
  s_cbranch_scc1 CS1_90
  s_waitcnt lgkmcnt(0)
IL0_89:
  s_barrier
  s_cmp_eq_u32 s3, 0
  s_cbranch_scc0 IL0_92
  s_and_b32 s80, s5, 7
  s_lshl_b32 s80, s80, 7
  s_lshl_b32 s82, s101, 13
  s_add_u32 s80, s80, s82
  s_add_u32 s80, s80, 0
  buffer_load_dwordx4 v[32:35], v3, s[24:27], s80 offen
  s_add_u32 s80, s80, 32768
  buffer_load_dwordx4 v[36:39], v3, s[24:27], s80 offen
  s_add_u32 s80, s80, 32768
  buffer_load_dwordx4 v[40:43], v3, s[24:27], s80 offen
  s_add_u32 s80, s80, 32768
  buffer_load_dwordx4 v[44:47], v3, s[24:27], s80 offen
  s_add_u32 s80, s80, 32768
  buffer_load_dwordx4 v[48:51], v3, s[24:27], s80 offen
  s_add_u32 s80, s80, 32768
  buffer_load_dwordx4 v[52:55], v3, s[24:27], s80 offen
  s_add_u32 s80, s80, 32768
  buffer_load_dwordx4 v[56:59], v3, s[24:27], s80 offen
  s_add_u32 s80, s80, 32768
  buffer_load_dwordx4 v[60:63], v3, s[24:27], s80 offen
  s_add_u32 s80, s80, 32768
  buffer_load_dwordx4 v[64:67], v3, s[24:27], s80 offen
  s_add_u32 s80, s80, 32768
  buffer_load_dwordx4 v[68:71], v3, s[24:27], s80 offen
  s_add_u32 s80, s80, 32768
  buffer_load_dwordx4 v[72:75], v3, s[24:27], s80 offen
  s_add_u32 s80, s80, 32768
  buffer_load_dwordx4 v[76:79], v3, s[24:27], s80 offen
  s_add_u32 s80, s80, 32768
  buffer_load_dwordx4 v[80:83], v3, s[24:27], s80 offen
  s_add_u32 s80, s80, 32768
  buffer_load_dwordx4 v[84:87], v3, s[24:27], s80 offen
  s_add_u32 s80, s80, 32768
  buffer_load_dwordx4 v[88:91], v3, s[24:27], s80 offen
IL0_92:
  s_barrier
  s_waitcnt vmcnt(0)
  s_lshl_b32 s80, s101, 10
  v_add_u32 v12, s80, v1
  v_add_u32 v13, 0x10000, v12
  v_add_u32 v14, 0x20000, v12
  ds_write_b128 v12, v[32:35] offset:28672
  ds_write_b128 v12, v[36:39] offset:32768
  ds_write_b128 v12, v[40:43] offset:36864
  ds_write_b128 v12, v[44:47] offset:40960
  ds_write_b128 v12, v[48:51] offset:45056
  ds_write_b128 v12, v[52:55] offset:49152
  ds_write_b128 v12, v[56:59] offset:53248
  ds_write_b128 v12, v[60:63] offset:57344
  ds_write_b128 v12, v[64:67] offset:61440
  s_lshr_b32 s80, s2, 3
  s_mul_i32 s80, s80, 24576
  s_mul_i32 s81, s101, 6144
  s_add_u32 s80, s80, s81
  s_add_u32 s80, s80, 491520
  s_mov_b32 exec_hi, 0xffff
  buffer_load_dword v23, v24, s[24:27], s80 offen
  s_mov_b64 exec, -1
  s_cmp_eq_u32 s3, 0
  s_cbranch_scc0 IL0_93
  s_lshr_b32 s80, s2, 3
  s_mul_i32 s80, s80, 17408
  s_mul_i32 s81, s101, 4352
  s_add_u32 s80, s80, s81
  s_add_u32 s80, s80, 1277952
  s_mov_b32 exec_hi, 0x3
  buffer_load_dword v23, v24, s[24:27], s80 offen
  s_mov_b64 exec, -1
  s_and_b32 s80, s5, 7
  s_lshl_b32 s80, s80, 7
  s_lshl_b32 s82, s101, 13
  s_add_u32 s80, s80, s82
  s_add_u32 s80, s80, 1277952
  buffer_load_dwordx4 v[92:95], v3, s[24:27], s80 offen
  s_add_u32 s80, s80, 32768
  buffer_load_dwordx4 v[96:99], v3, s[24:27], s80 offen
  s_add_u32 s80, s80, 32768
  buffer_load_dwordx4 v[100:103], v3, s[24:27], s80 offen
  s_add_u32 s80, s80, 32768
  buffer_load_dwordx4 v[104:107], v3, s[24:27], s80 offen
  s_add_u32 s80, s80, 32768
  buffer_load_dwordx4 v[108:111], v3, s[24:27], s80 offen
  s_add_u32 s80, s80, 32768
  buffer_load_dwordx4 v[112:115], v3, s[24:27], s80 offen
  s_add_u32 s80, s80, 32768
  buffer_load_dwordx4 v[116:119], v3, s[24:27], s80 offen
  s_add_u32 s80, s80, 32768
  buffer_load_dwordx4 v[120:123], v3, s[24:27], s80 offen
  s_add_u32 s80, s80, 32768
  buffer_load_dwordx4 v[124:127], v3, s[24:27], s80 offen
  s_add_u32 s80, s80, 32768
  buffer_load_dwordx4 v[128:131], v3, s[24:27], s80 offen
  s_add_u32 s80, s80, 32768
  buffer_load_dwordx4 v[132:135], v3, s[24:27], s80 offen
  s_add_u32 s80, s80, 32768
  buffer_load_dwordx4 v[136:139], v3, s[24:27], s80 offen
  s_add_u32 s80, s80, 32768
  buffer_load_dwordx4 v[140:143], v3, s[24:27], s80 offen
  s_add_u32 s80, s80, 32768
  buffer_load_dwordx4 v[144:147], v3, s[24:27], s80 offen
  s_add_u32 s80, s80, 32768
  buffer_load_dwordx4 v[148:151], v3, s[24:27], s80 offen
  s_add_u32 s80, s80, 32768
  buffer_load_dwordx4 v[152:155], v3, s[24:27], s80 offen
  s_add_u32 s80, s80, 32768
  buffer_load_dwordx4 v[156:159], v3, s[24:27], s80 offen
IL0_93:
  s_barrier
  s_and_b32 s80, s5, 7
  s_lshl_b32 s80, s80, 7
  s_lshl_b32 s82, s101, 13
  s_add_u32 s80, s80, s82
  s_add_u32 s80, s80, 491520
  s_lshl_b32 s81, s101, 10
  s_add_u32 s81, s81, 90112
  s_mov_b32 s98, 17
DMA_94:
  s_mov_b32 m0, s81
  s_add_u32 s81, s81, 4096
  buffer_load_dwordx4 v3, s[24:27], s80 offen  lds
  s_add_u32 s80, s80, 32768
  s_sub_u32 s98, s98, 1
  s_cmp_lg_u32 s98, 0
  s_cbranch_scc1 DMA_94
  s_and_b32 s80, s5, 7
  s_lshl_b32 s80, s80, 7
  s_lshl_b32 s82, s101, 13
  s_add_u32 s80, s80, s82
  s_add_u32 s80, s80, 1048576
  s_lshl_b32 s81, s101, 10
  s_add_u32 s81, s81, 0
  s_mov_b32 s98, 7
DMA_95:
  s_mov_b32 m0, s81
  s_add_u32 s81, s81, 4096
  buffer_load_dwordx4 v3, s[24:27], s80 offen  lds
  s_add_u32 s80, s80, 32768
  s_sub_u32 s98, s98, 1
  s_cmp_lg_u32 s98, 0
  s_cbranch_scc1 DMA_95
  ds_write_b128 v13, v[68:71] offset:0
  ds_write_b128 v13, v[72:75] offset:4096
  ds_write_b128 v13, v[76:79] offset:8192
  ds_write_b128 v13, v[80:83] offset:12288
  ds_write_b128 v13, v[84:87] offset:16384
  ds_write_b128 v13, v[88:91] offset:20480
  s_waitcnt vmcnt(0) lgkmcnt(0)
  s_barrier
  s_barrier
  s_waitcnt lgkmcnt(0)
  ds_write_b128 v12, v[92:95] offset:28672
  ds_write_b128 v12, v[96:99] offset:32768
  ds_write_b128 v12, v[100:103] offset:36864
  ds_write_b128 v12, v[104:107] offset:40960
  ds_write_b128 v12, v[108:111] offset:45056
  ds_write_b128 v12, v[112:115] offset:49152
  ds_write_b128 v12, v[116:119] offset:53248
  ds_write_b128 v12, v[120:123] offset:57344
  ds_write_b128 v12, v[124:127] offset:61440
  ds_write_b128 v13, v[128:131] offset:0
  ds_write_b128 v13, v[132:135] offset:4096
  ds_write_b128 v13, v[136:139] offset:8192
  ds_write_b128 v13, v[140:143] offset:12288
  ds_write_b128 v13, v[144:147] offset:16384
  ds_write_b128 v13, v[148:151] offset:20480
  ds_write_b128 v13, v[152:155] offset:24576
  ds_write_b128 v13, v[156:159] offset:28672
  s_waitcnt lgkmcnt(0)
  s_barrier
  s_barrier
  s_add_u32 s3, s3, 1
  s_add_u32 s46, s46, 1
  s_cmp_lt_u32 s3, 2
  s_cbranch_scc1 L_HLAYER
  s_branch L_END
L_BAIL:
  s_mov_b64 exec, -1
L_END:
  s_endpgm
L_CODE_END:

.section .rodata,"a"
.p2align 6
.amdhsa_kernel interleave_layers__sliding_block__dense_activation_squared_relu__prompt_kernel
  .amdhsa_next_free_vgpr 256
  .amdhsa_next_free_sgpr 102
  .amdhsa_accum_offset 256
  .amdhsa_group_segment_fixed_size 0
  .amdhsa_kernarg_size 88
  .amdhsa_user_sgpr_count 2
  .amdhsa_user_sgpr_kernarg_segment_ptr 1
  .amdhsa_system_sgpr_workgroup_id_x 1
.end_amdhsa_kernel
```
